```python
import torch

def _softmax(x, axis=-1):
    return torch.softmax(x, dim=axis)

def _gelu(x):
    return torch.nn.functional.gelu(x, approximate='tanh')

def _silu(x):
    return torch.nn.functional.silu(x)

def _sigmoid(x):
    return torch.sigmoid(x)

def _layernorm(x, axis=-1, eps=1e-05):
    m = x.mean(dim=axis, keepdim=True)
    v = x.var(dim=axis, keepdim=True, unbiased=False)
    return (x - m) / torch.sqrt(v + eps)

def _scatter_add(tgt, idx, src, axis=0):
    return tgt.clone().index_add_(axis, idx, src)

def _segment_sum(src, seg, n):
    out = torch.zeros((n,) + src.shape[1:], dtype=src.dtype)
    return out.index_add_(0, seg, src)

def _pad(x, pw):
    flat = tuple((v for pair in reversed(pw) for v in pair))
    return torch.nn.functional.pad(x, flat)
kernel_name = 'adaLN_cond__gqa_block_cached__glu_gated_geglu__decode'

def setup_inputs():

    _w = lambda a: (lambda t: t.to(torch.bfloat16) if t.is_floating_point() else t)(torch.as_tensor(a))

    def _A_setup():
        B, Sq, D = (8, 1, 576)
        Hq, Hkv, Sk, Dh = (32, 16, 8192, 128)
        assert Hq % Hkv == 0, (Hq, Hkv)
        return {'x': _w((lambda *s: torch.randn(*s, dtype=torch.bfloat16) * 0.1)(B, Sq, D)), 'k_cache': _w((lambda *s: torch.randn(*s, dtype=torch.bfloat16) * 0.8)(B, Hkv, Sk, Dh)), 'v_cache': _w((lambda *s: torch.randn(*s, dtype=torch.bfloat16) * 3.2)(B, Hkv, Sk, Dh)), 'wq': _w((lambda *s: torch.randn(*s, dtype=torch.bfloat16) * 0.8)(D, Hq * Dh) * D ** (-0.5)), 'wo': _w((lambda *s: torch.randn(*s, dtype=torch.bfloat16) * 3.2)(Hq * Dh, D) * (Hq * Dh) ** (-0.5))}
    _A_in = _A_setup()

    def _B_setup():
        B, S, Dm, Df = (8, 1, 576, 4608)
        return {'x': _w((lambda *s: torch.randn(*s, dtype=torch.bfloat16) * 0.1)(B, S, Dm)), 'w_gate': _w((lambda *s: torch.randn(*s, dtype=torch.bfloat16) * 3.2)(Dm, Df) * Dm ** (-0.5)), 'w_up': _w((lambda *s: torch.randn(*s, dtype=torch.bfloat16) * 3.2)(Dm, Df) * Dm ** (-0.5)), 'w_down': _w((lambda *s: torch.randn(*s, dtype=torch.bfloat16) * 3.2)(Df, Dm) * Df ** (-0.5))}
    _B_in = _B_setup()
    return {'A_x': _A_in['x'], 'A_k_cache': _A_in['k_cache'], 'A_v_cache': _A_in['v_cache'], 'A_wq': _A_in['wq'], 'A_wo': _A_in['wo'], 'B_x': _B_in['x'], 'B_w_gate': _B_in['w_gate'], 'B_w_up': _B_in['w_up'], 'B_w_down': _B_in['w_down'], 'c': _w((lambda *s: torch.randn(*s, dtype=torch.bfloat16) * 0.4)(8, 576) * 8.0), 'w_mod': _w((lambda *s: torch.randn(*s, dtype=torch.bfloat16) * 0.4)(576, 6 * 576) * 576 ** (-0.5) * 8.0)}

def reference(A_x, A_k_cache, A_v_cache, A_wq, A_wo, B_x, B_w_gate, B_w_up, B_w_down, c, w_mod):

    def _A_ref(x, k_cache, v_cache, wq, wo):
        B, Sq, D = x.shape
        Hq, Dh = (32, 128)
        Hkv = k_cache.shape[1]
        rep = Hq // Hkv
        q = (lambda x, *d: x.permute(*d))((x @ wq).reshape(B, Sq, Hq, Dh), 0, 2, 1, 3)
        k = (lambda x, n, axis: torch.repeat_interleave(x, n, dim=axis))(k_cache, rep, axis=1)
        v = (lambda x, n, axis: torch.repeat_interleave(x, n, dim=axis))(v_cache, rep, axis=1)
        scores = torch.einsum('bhqd,bhkd->bhqk', q, k) * Dh ** (-0.5)
        p = _softmax(scores, axis=-1)
        o = torch.einsum('bhqk,bhkd->bhqd', p, v)
        return (lambda x, *d: x.permute(*d))(o, 0, 2, 1, 3).reshape(B, Sq, Hq * Dh) @ wo

    def _B_ref(x, w_gate, w_up, w_down):
        g = torch.einsum('bsd,df->bsf', x, w_gate)
        u = torch.einsum('bsd,df->bsf', x, w_up)
        h = _gelu(g) * u
        return torch.einsum('bsf,fd->bsd', h, w_down)
    x = A_x
    mod = (_silu(c) @ w_mod).reshape(c.shape[0], 6, 1, -1)
    sa, ca, ga, sb, cb, gb = (mod[:, 0].clone(), mod[:, 1].clone(), mod[:, 2].clone(), mod[:, 3].clone(), mod[:, 4].clone(), mod[:, 5].clone())
    h = _layernorm(x, axis=-1) * (1 + ca) + sa
    x = x + ga * _A_ref(h, A_k_cache, A_v_cache, A_wq, A_wo)
    h = _layernorm(x, axis=-1) * (1 + cb) + sb
    x = x + gb * _B_ref(h, B_w_gate, B_w_up, B_w_down)
    return x
```

```asm
; @launch grid=(256,1,1) block=(512,1,1) lds=159488
.amdgcn_target "amdgcn-amd-amdhsa--gfx950"
.text
.globl adaLN_cond__gqa_block_cached__glu_gated_geglu__decode_kernel
.p2align 8
.type adaLN_cond__gqa_block_cached__glu_gated_geglu__decode_kernel,@function
adaLN_cond__gqa_block_cached__glu_gated_geglu__decode_kernel:
  s_cmpk_ge_u32 s2, 256
  s_cbranch_scc1 L_end
  s_load_dwordx16 s[16:31], s[0:1], 0
  s_load_dwordx8 s[32:39], s[0:1], 64
  s_load_dwordx4 s[40:43], s[0:1], 96
  v_lshrrev_b32 v1, 6, v0
  v_and_b32 v0, 63, v0
  s_and_b32 s4, s2, 7
  v_readfirstlane_b32 s3, v1
  s_lshr_b32 s5, s2, 3
  s_and_b32 s12, s5, 1
  s_lshl_b32 s13, s4, 1
  s_add_u32 s12, s12, s13
  s_bfe_u32 s13, s5, 0x30001
  s_lshr_b32 s14, s5, 4
  s_cmp_lg_u32 s3, 0
  s_cbranch_scc1 L_rest
  s_memrealtime s[52:53]
  v_lshrrev_b32 v2, 4, v0
  v_lshlrev_b32 v2, 6, v2
  v_and_b32 v3, 3, v0
  v_lshl_add_u32 v2, v3, 4, v2
  v_bfe_u32 v3, v0, 2, 2
  v_lshl_add_u32 v2, v3, 8, v2
  v_lshlrev_b32 v3, 4, v0
  s_lshl_b32 s6, s13, 4
  s_add_u32 s6, s6, s12
  s_lshl_b32 s6, s6, 21
  s_mov_b32 s7, 0
  s_mov_b32 s8, 0
  s_mov_b32 s46, 0x10000000
  s_mov_b32 s47, 0x20000
  s_setprio 2
  s_lshl_b32 s10, s14, 16
  s_add_u32 s6, s6, s10
  s_lshr_b32 s100, s5, 1
  s_add_u32 s100, s100, s4
  s_and_b32 s100, s100, 7
  s_lshl_b32 s100, s100, 12
  s_and_b32 s10, s100, 0x3000
  s_and_b32 s100, s100, 0xc000
  v_or_b32 v2, s10, v2
  v_or_b32 v9, s10, v3
  s_xor_b32 s10, s6, s100
  v_xor_b32 v12, 4096, v2
  v_xor_b32 v13, 8192, v2
  v_xor_b32 v14, 12288, v2
  s_xor_b32 s101, s6, 0
  s_sub_u32 s11, s2, 72
  s_cmp_lt_u32 s11, 9
  s_cselect_b32 s11, 255, s2
  s_cmp_ge_u32 s11, 252
  s_waitcnt lgkmcnt(0)
  s_mov_b32 s44, s18
  s_mov_b32 s45, s19
  s_cbranch_scc1 L_ldp
  s_add_u32 m0, s8, 0
  s_nop 0
  buffer_load_dwordx4 v2, s[44:47], s10 offen offset:0 nt lds
  buffer_load_dwordx4 v2, s[44:47], s10 offen offset:1024 nt lds
  buffer_load_dwordx4 v2, s[44:47], s10 offen offset:2048 nt lds
  buffer_load_dwordx4 v2, s[44:47], s10 offen offset:3072 nt lds
  s_add_u32 m0, s8, 4096
  s_nop 0
  buffer_load_dwordx4 v12, s[44:47], s10 offen offset:0 nt lds
  buffer_load_dwordx4 v12, s[44:47], s10 offen offset:1024 nt lds
  buffer_load_dwordx4 v12, s[44:47], s10 offen offset:2048 nt lds
  buffer_load_dwordx4 v12, s[44:47], s10 offen offset:3072 nt lds
  s_add_u32 m0, s8, 8192
  s_nop 0
  buffer_load_dwordx4 v13, s[44:47], s10 offen offset:0 nt lds
  buffer_load_dwordx4 v13, s[44:47], s10 offen offset:1024 nt lds
  buffer_load_dwordx4 v13, s[44:47], s10 offen offset:2048 nt lds
  buffer_load_dwordx4 v13, s[44:47], s10 offen offset:3072 nt lds
  s_add_u32 m0, s8, 12288
  s_nop 0
  buffer_load_dwordx4 v14, s[44:47], s10 offen offset:0 nt lds
  buffer_load_dwordx4 v14, s[44:47], s10 offen offset:1024 nt lds
  buffer_load_dwordx4 v14, s[44:47], s10 offen offset:2048 nt lds
  buffer_load_dwordx4 v14, s[44:47], s10 offen offset:3072 nt lds
  s_barrier
  s_branch L_ld0b
L_ldp:
  s_getpc_b64 s[56:57]
L_pc0:
  s_add_u32 s56, s56, L_pH-L_pc0
  s_addc_u32 s57, s57, 0
  v_add_u32 v5, 0, v3
  global_load_dwordx4 v[16:19], v5, s[56:57]
  v_add_u32 v5, 1024, v3
  global_load_dwordx4 v[20:23], v5, s[56:57]
  v_add_u32 v5, 2048, v3
  global_load_dwordx4 v[24:27], v5, s[56:57]
  v_add_u32 v5, 3072, v3
  global_load_dwordx4 v[28:31], v5, s[56:57]
  v_add_u32 v5, 4096, v3
  global_load_dwordx4 v[32:35], v5, s[56:57]
  v_add_u32 v5, 5120, v3
  global_load_dwordx4 v[36:39], v5, s[56:57]
  v_add_u32 v5, 6144, v3
  global_load_dwordx4 v[40:43], v5, s[56:57]
  v_add_u32 v5, 7168, v3
  global_load_dwordx4 v[44:47], v5, s[56:57]
  v_add_u32 v5, 8192, v3
  global_load_dwordx4 v[48:51], v5, s[56:57]
  s_barrier
  v_mov_b32 v5, 147492
  s_mov_b32 s58, 60606060
sp_1:
  ds_read_b32 v6, v5
  s_waitcnt lgkmcnt(0)
  v_readfirstlane_b32 s56, v6
  s_cmp_ge_u32 s56, 4
  s_cbranch_scc1 sp_1_ok
  s_sleep 2
  s_sub_u32 s58, s58, 1
  s_cbranch_scc0 sp_1
sp_1_ok:
  s_waitcnt vmcnt(0)
  s_add_u32 m0, s8, 0
  s_nop 0
  buffer_load_dwordx4 v2, s[44:47], s10 offen offset:0 nt lds
  buffer_load_dwordx4 v2, s[44:47], s10 offen offset:1024 nt lds
  buffer_load_dwordx4 v2, s[44:47], s10 offen offset:2048 nt lds
  buffer_load_dwordx4 v2, s[44:47], s10 offen offset:3072 nt lds
  s_add_u32 m0, s8, 4096
  s_nop 0
  buffer_load_dwordx4 v12, s[44:47], s10 offen offset:0 nt lds
  buffer_load_dwordx4 v12, s[44:47], s10 offen offset:1024 nt lds
  buffer_load_dwordx4 v12, s[44:47], s10 offen offset:2048 nt lds
  buffer_load_dwordx4 v12, s[44:47], s10 offen offset:3072 nt lds
  s_add_u32 m0, s8, 8192
  s_nop 0
  buffer_load_dwordx4 v13, s[44:47], s10 offen offset:0 nt lds
  buffer_load_dwordx4 v13, s[44:47], s10 offen offset:1024 nt lds
  buffer_load_dwordx4 v13, s[44:47], s10 offen offset:2048 nt lds
  buffer_load_dwordx4 v13, s[44:47], s10 offen offset:3072 nt lds
  s_add_u32 m0, s8, 12288
  s_nop 0
  buffer_load_dwordx4 v14, s[44:47], s10 offen offset:0 nt lds
  buffer_load_dwordx4 v14, s[44:47], s10 offen offset:1024 nt lds
  buffer_load_dwordx4 v14, s[44:47], s10 offen offset:2048 nt lds
  buffer_load_dwordx4 v14, s[44:47], s10 offen offset:3072 nt lds
L_ld0b:
  s_add_u32 s7, s7, 1
  v_xor_b32 v2, 0x2000, v2
  v_xor_b32 v12, 0x2000, v12
  v_xor_b32 v13, 0x2000, v13
  v_xor_b32 v14, 0x2000, v14
  s_add_u32 s6, s6, 16384
  s_and_b32 s63, s6, 65535
  s_cselect_b32 s63, 0, 65536
  s_add_u32 s6, s6, s63
  s_xor_b32 s10, s6, s100
  s_add_u32 s8, s8, 16384
  s_cmp_eq_u32 s8, 147456
  s_cselect_b32 s8, 0, s8
  s_mov_b32 s9, 147476
  v_mov_b32 v5, s9
  v_mov_b32 v6, 0
  s_mov_b32 s62, 0x00c0000f
  v_mov_b32 v4, 147456
  s_add_u32 s55, s4, s5
  s_and_b32 s55, s55, 7
  s_cmp_eq_u32 s55, 3
  s_movk_i32 s55, 396
  s_cselect_b32 s55, 1005, s55
  s_cmp_lt_u32 s5, 9
  s_cselect_b32 s55, s55, 0
  s_sub_u32 s97, s2, 72
  s_cmp_lt_u32 s97, 9
  s_cselect_b32 s97, 7, 64
  s_add_u32 s50, s52, 230
  s_movk_i32 s51, 13900
  s_mov_b32 s48, 0
  s_mov_b32 s49, 0
  s_mov_b32 s59, 0
  s_mov_b32 s96, s52
  s_mov_b32 s98, 0x56422e1a
  s_mov_b32 s99, 0x68
  v_mov_b32 v8, 147512
  v_mov_b32 v16, 0
  v_mov_b32 v17, 0
  v_mov_b32 v10, 147628
  v_mov_b32 v7, 0
  s_mov_b32 s57, -2
L_ld1:
  s_sub_u32 s11, s7, 8
  s_waitcnt lgkmcnt(0)
  v_readfirstlane_b32 s56, v6
  v_readfirstlane_b32 s60, v16
  v_readfirstlane_b32 s61, v17
  s_cmp_ge_i32 s56, s11
  s_cbranch_scc0 L_ld1_full
L_ld1_go:
  s_cmp_eq_u32 s61, 0
  s_cselect_b64 s[60:61], s[50:51], s[60:61]
  s_cmp_eq_u32 s60, s50
  s_cselect_b32 s49, s49, s59
  s_mov_b64 s[50:51], s[60:61]
  s_sub_u32 s54, s52, s96
  s_mov_b32 s96, s52
  s_lshr_b32 s63, s51, 8
  s_sub_i32 s54, s54, s63
  s_cmp_gt_i32 s54, 100
  s_cselect_b32 s54, s54, 0
  s_add_u32 s48, s48, s54
  s_sub_i32 s54, s7, 40
  s_max_i32 s54, s54, 0
  s_mul_i32 s54, s54, s55
  s_lshr_b32 s54, s54, 8
  s_add_u32 s54, s54, s52
  s_and_b32 s63, s98, 255
  s_cmp_eq_u32 s63, s7
  s_cbranch_scc1 L_ts
L_ts_r:
  s_mul_i32 s60, s7, s51
  s_lshr_b32 s60, s60, 8
  s_add_u32 s60, s60, s50
  s_sub_u32 s60, s54, s60
  s_sub_u32 s60, s60, s48
  s_add_u32 s60, s60, s49
  s_bfe_i32 s60, s60, 0x140000
  s_mul_i32 s60, s60, 28
  s_ashr_i32 s60, s60, 4
  s_add_i32 s60, s60, 324
  s_max_i32 s60, s60, 240
  s_min_i32 s60, s60, 450
  s_cmp_lt_u32 s7, 10
  s_cselect_b32 s48, 0, s48
  s_cmp_lt_u32 s7, 8
  s_cselect_b32 s60, 360, s60
  s_mul_i32 s63, s7, 7
  s_and_b32 s63, s63, 15
  s_add_u32 s60, s60, s63
  s_lshr_b32 s60, s60, 4
  s_cmp_ge_u32 s7, 124
  s_cselect_b32 s60, 28, s60
  s_lshl_b32 s63, s60, 18
  s_or_b32 s61, s60, s63
  s_and_b32 s61, s61, s62
  s_add_u32 m0, s8, 0
pc_2:
  s_getreg_b32 s63, hwreg(HW_REG_IB_STS)
  s_and_b32 s63, s63, s62
  s_cmp_ge_u32 s63, s61
  s_cbranch_scc1 pc_2
  buffer_load_dwordx4 v2, s[44:47], s10 offen offset:0 nt lds
  buffer_load_dwordx4 v2, s[44:47], s10 offen offset:1024 nt lds
  buffer_load_dwordx4 v2, s[44:47], s10 offen offset:2048 nt lds
  buffer_load_dwordx4 v2, s[44:47], s10 offen offset:3072 nt lds
  s_add_u32 m0, s8, 4096
pc_3:
  s_getreg_b32 s63, hwreg(HW_REG_IB_STS)
  s_and_b32 s63, s63, s62
  s_cmp_ge_u32 s63, s61
  s_cbranch_scc1 pc_3
  buffer_load_dwordx4 v12, s[44:47], s10 offen offset:0 nt lds
  buffer_load_dwordx4 v12, s[44:47], s10 offen offset:1024 nt lds
  buffer_load_dwordx4 v12, s[44:47], s10 offen offset:2048 nt lds
  buffer_load_dwordx4 v12, s[44:47], s10 offen offset:3072 nt lds
  s_add_u32 s57, s57, 1
  s_waitcnt vmcnt(32)
  v_max_i32 v7, s57, v7
  ds_write_b32 v4, v7
  s_add_u32 m0, s8, 8192
pc_4:
  s_getreg_b32 s63, hwreg(HW_REG_IB_STS)
  s_and_b32 s63, s63, s62
  s_cmp_ge_u32 s63, s61
  s_cbranch_scc1 pc_4
  buffer_load_dwordx4 v13, s[44:47], s10 offen offset:0 nt lds
  buffer_load_dwordx4 v13, s[44:47], s10 offen offset:1024 nt lds
  buffer_load_dwordx4 v13, s[44:47], s10 offen offset:2048 nt lds
  buffer_load_dwordx4 v13, s[44:47], s10 offen offset:3072 nt lds
  s_cmp_lg_u32 s7, 72
  s_cselect_b32 s63, 4, 0
  s_add_u32 s9, s9, s63
  s_cmp_eq_u32 s9, 147484
  s_cselect_b32 s9, 147472, s9
  v_mov_b32 v5, s9
  ds_read_b32 v6, v5
  ds_read_b64 v[16:17], v8
  s_memrealtime s[52:53]
  s_add_u32 m0, s8, 12288
pc_5:
  s_getreg_b32 s63, hwreg(HW_REG_IB_STS)
  s_and_b32 s63, s63, s62
  s_cmp_ge_u32 s63, s61
  s_cbranch_scc1 pc_5
  buffer_load_dwordx4 v14, s[44:47], s10 offen offset:0 nt lds
  buffer_load_dwordx4 v14, s[44:47], s10 offen offset:1024 nt lds
  buffer_load_dwordx4 v14, s[44:47], s10 offen offset:2048 nt lds
  buffer_load_dwordx4 v14, s[44:47], s10 offen offset:3072 nt lds
  s_add_u32 s57, s57, 1
  s_waitcnt vmcnt(32)
  v_max_i32 v7, s57, v7
  ds_write_b32 v4, v7
  s_add_u32 s7, s7, 1
  v_xor_b32 v2, 0x2000, v2
  v_xor_b32 v12, 0x2000, v12
  v_xor_b32 v13, 0x2000, v13
  v_xor_b32 v14, 0x2000, v14
  s_add_u32 s6, s6, 16384
  s_and_b32 s63, s6, 65535
  s_cselect_b32 s63, 0, 65536
  s_add_u32 s6, s6, s63
  s_xor_b32 s10, s6, s100
  s_add_u32 s8, s8, 16384
  s_cmp_eq_u32 s8, 147456
  s_cselect_b32 s8, 0, s8
  s_cmp_eq_u32 s7, s97
  s_cbranch_scc1 L_sw
L_sw_r:
  s_cmp_lt_u32 s7, 128
  s_cbranch_scc1 L_ld1
  s_add_u32 s57, s57, 1
  v_max_i32 v7, s57, v7
  s_waitcnt vmcnt(24)
  ds_write_b32 v4, v7
  s_add_u32 s57, s57, 1
  v_max_i32 v7, s57, v7
  s_waitcnt vmcnt(16)
  ds_write_b32 v4, v7
  s_add_u32 s57, s57, 1
  v_max_i32 v7, s57, v7
  s_waitcnt vmcnt(8)
  ds_write_b32 v4, v7
  s_add_u32 s57, s57, 1
  v_max_i32 v7, s57, v7
  s_waitcnt vmcnt(0)
  ds_write_b32 v4, v7
  s_waitcnt lgkmcnt(0)
  s_endpgm
L_ts:
  s_lshr_b64 s[98:99], s[98:99], 8
  v_add_u32 v10, 4, v10
  s_bitset1_b32 s54, 30
  s_bitset0_b32 s54, 31
  s_mov_b32 s59, s48
  v_mov_b32 v11, s48
  ds_write_b32 v10, v11 offset:40
  v_mov_b32 v18, s54
  ds_write_b32 v10, v18
  s_branch L_ts_r
L_sw:
  s_cmp_eq_u32 s7, 64
  s_cbranch_scc1 L_sw2
  s_mov_b32 s97, 64
  v_mov_b32 v18, 147492
  s_mov_b32 s58, 83333333
sp_6:
  ds_read_b32 v19, v18
  s_waitcnt lgkmcnt(0)
  v_readfirstlane_b32 s63, v19
  s_cmp_ge_u32 s63, 8
  s_cbranch_scc1 sp_6_ok
  s_sleep 1
  s_sub_u32 s58, s58, 1
  s_cbranch_scc0 sp_6
sp_6_ok:
  s_branch L_sw_r
L_sw2:
  s_mov_b32 s6, s101
  s_mov_b32 s44, s20
  s_mov_b32 s45, s21
  s_xor_b32 s10, s6, s100
  v_mov_b32 v2, v9
  v_xor_b32 v12, 4096, v2
  v_xor_b32 v13, 8192, v2
  v_xor_b32 v14, 12288, v2
  s_branch L_sw_r
L_ld1_full:
  ds_read_b32 v6, v5
  s_waitcnt lgkmcnt(0)
  v_readfirstlane_b32 s56, v6
  s_cmp_ge_i32 s56, s11
  s_cbranch_scc1 L_ld1_go
  s_lshl_b32 s63, s7, 1
  v_mov_b32 v7, s63
  s_waitcnt vmcnt(0)
  ds_write_b32 v4, v7
  s_mov_b32 s58, 83333333
sp_7:
  ds_read_b32 v6, v5
  s_waitcnt lgkmcnt(0)
  v_readfirstlane_b32 s56, v6
  s_cmp_ge_i32 s56, s11
  s_cbranch_scc1 sp_7_ok
  s_sleep 1
  s_sub_u32 s58, s58, 1
  s_cbranch_scc0 sp_7
sp_7_ok:
  s_branch L_ld1_go
L_rest:
  s_mov_b32 s15, 0x200000
  s_cmp_lt_u32 s2, 252
  s_cbranch_scc1 L_noca
  v_mov_b32 v8, -1
  v_mov_b32 v9, -1
  v_mov_b32 v10, -1
  v_mov_b32 v11, -1
  v_lshlrev_b32 v3, 4, v0
  s_sub_u32 s6, s2, 252
  s_mul_i32 s6, s6, 7
  s_add_u32 s6, s6, s3
  s_sub_u32 s6, s6, 1
  s_mul_i32 s6, s6, 3072
  s_waitcnt lgkmcnt(0)
  s_mov_b32 s48, s42
  s_mov_b32 s49, s43
  s_mov_b32 s50, 1064960
  s_mov_b32 s51, 0x20000
  buffer_store_dwordx4 v[8:11], v3, s[48:51], s6 offen offset:0 sc1
  buffer_store_dwordx4 v[8:11], v3, s[48:51], s6 offen offset:1024 sc1
  buffer_store_dwordx4 v[8:11], v3, s[48:51], s6 offen offset:2048 sc1
  s_waitcnt vmcnt(0)
L_noca:
  s_cmp_ge_u32 s3, 4
  s_cbranch_scc1 L_aux
  s_sub_u32 s9, s3, 1
  s_mul_i32 s6, s5, 18
  s_mul_i32 s7, s9, 6
  s_add_u32 s8, s6, s7
  s_mul_i32 s6, s8, 6912
  s_lshl_b32 s7, s4, 7
  s_add_u32 s6, s6, s7
  v_and_b32 v2, 7, v0
  v_lshlrev_b32 v2, 4, v2
  v_bfe_u32 v3, v0, 3, 1
  v_mul_u32_u24 v3, 1152, v3
  v_add_u32 v2, v2, v3
  v_lshrrev_b32 v3, 4, v0
  v_mul_u32_u24 v4, 6912, v3
  v_add_u32 v4, v4, v2
  v_and_b32 v3, 1, v3
  v_add_u32 v3, 4, v3
  v_mul_u32_u24 v3, 6912, v3
  v_add_u32 v3, v3, v2
  s_waitcnt lgkmcnt(0)
  s_mov_b32 s44, s36
  s_mov_b32 s45, s37
  s_mov_b32 s46, 3981312
  s_mov_b32 s47, 0x20000
  buffer_load_dwordx4 v[40:43], v4, s[44:47], s6 offen
  buffer_load_dwordx4 v[44:47], v3, s[44:47], s6 offen
  s_cmp_lg_u32 s4, 0
  s_cbranch_scc1 L_pf1
  buffer_load_dwordx4 v[48:51], v4, s[44:47], s6 offen offset:1024
  buffer_load_dwordx4 v[52:55], v3, s[44:47], s6 offen offset:1024
L_pf1:
  v_lshlrev_b32 v2, 4, v0
  s_lshl_b32 s6, s8, 13
  s_lshl_b32 s7, s4, 10
  s_add_u32 s6, s6, s7
  s_mov_b32 s44, s22
  s_mov_b32 s45, s23
  s_mov_b32 s46, 4718592
  s_mov_b32 s47, 0x20000
  buffer_load_dwordx4 v[16:19], v2, s[44:47], s6 offen
  s_add_u32 s6, s6, 8192
  buffer_load_dwordx4 v[20:23], v2, s[44:47], s6 offen
  s_add_u32 s6, s6, 8192
  buffer_load_dwordx4 v[24:27], v2, s[44:47], s6 offen
  s_add_u32 s6, s6, 8192
  buffer_load_dwordx4 v[28:31], v2, s[44:47], s6 offen
  s_add_u32 s6, s6, 8192
  buffer_load_dwordx4 v[32:35], v2, s[44:47], s6 offen
  s_add_u32 s6, s6, 8192
  buffer_load_dwordx4 v[36:39], v2, s[44:47], s6 offen
  v_lshlrev_b32 v9, 4, v0
  v_mov_b32 v10, 147456
  v_mov_b32 v5, 0xff800000
  v_mov_b32 v6, 0
  s_mov_b32 s60, 0x05040100
  s_mov_b32 s61, 0x07060302
  v_mov_b32 v128, 0
  v_mov_b32 v129, 0
  v_mov_b32 v130, 0
  v_mov_b32 v131, 0
  v_and_b32 v2, 1, v0
  v_lshlrev_b32 v2, 8, v2
  v_lshrrev_b32 v3, 2, v0
  v_lshl_add_u32 v2, v3, 4, v2
  s_lshl_b32 s6, s13, 13
  s_lshl_b32 s7, s12, 9
  s_add_u32 s6, s6, s7
  s_add_u32 s6, s6, 9216
  s_waitcnt lgkmcnt(0)
  s_mov_b32 s48, s42
  s_mov_b32 s49, s43
  s_mov_b32 s50, 1064960
  s_mov_b32 s51, 0x20000
  s_mov_b32 s52, s40
  s_mov_b32 s53, s41
  s_mov_b32 s54, 256
  s_mov_b32 s55, 0x20000
  v_add_u32 v224, 156416, v9
  s_lshl_b32 s57, s9, 10
  v_add_u32 v13, s57, v224
  v_and_b32 v4, 1, v0
  v_lshlrev_b32 v225, 6, v4
  v_lshrrev_b32 v226, 2, v0
  v_lshlrev_b32 v226, 8, v226
  v_lshl_add_u32 v226, v4, 12, v226
  v_bfe_u32 v3, v0, 1, 1
  v_lshl_add_u32 v226, v3, 3, v226
  v_mov_b32 v227, v225
  v_mov_b32 v228, 147500
  s_lshl_b32 s57, s14, 3
  s_add_u32 s57, s57, s13
  s_lshl_b32 s96, s12, 13
  s_lshl_b32 s0, s57, 4
  s_add_u32 s96, s96, s0
  s_add_u32 s96, s96, 122880
  s_lshl_b32 s0, s12, 3
  s_add_u32 s0, s0, s13
  s_lshl_b32 s0, s0, 7
  s_lshl_b32 s57, s14, 5
  s_add_u32 s0, s0, s57
  s_add_u32 s0, s0, 253952
  s_mov_b32 s7, s9
  s_lshl_b32 s8, s9, 14
  s_lshl_b32 s11, s9, 2
  s_add_u32 s11, s11, 147472
  v_mov_b32 v15, s11
  s_mov_b32 s56, 0
  s_add_u32 s97, s9, 91
  s_mov_b32 s10, 0x00030003
  s_mov_b32 s11, 0x00030003
  s_barrier
  s_waitcnt vmcnt(0)
  v_add_u32 v12, s8, v9
  s_lshl_b32 s57, s7, 1
  s_add_u32 s57, s57, 2
  s_cmp_ge_u32 s56, s57
  s_cbranch_scc1 wl_8
  s_mov_b32 s58, 39215686
sp_9:
  ds_read_b32 v7, v10
  s_waitcnt lgkmcnt(0)
  v_readfirstlane_b32 s56, v7
  s_cmp_ge_u32 s56, s57
  s_cbranch_scc1 sp_9_ok
  s_sleep 4
  s_sub_u32 s58, s58, 1
  s_cbranch_scc0 sp_9
sp_9_ok:
wl_8:
  ds_read_b128 v[16:19], v12 offset:0
  ds_read_b128 v[20:23], v12 offset:1024
  ds_read_b128 v[24:27], v12 offset:2048
  ds_read_b128 v[28:31], v12 offset:3072
  ds_read_b128 v[32:35], v12 offset:4096
  ds_read_b128 v[36:39], v12 offset:5120
  ds_read_b128 v[40:43], v12 offset:6144
  ds_read_b128 v[44:47], v12 offset:7168
  ds_read_b128 v[48:51], v12 offset:8192
  ds_read_b128 v[52:55], v12 offset:9216
  ds_read_b128 v[56:59], v12 offset:10240
  ds_read_b128 v[60:63], v12 offset:11264
  s_waitcnt lgkmcnt(8)
  ds_read_b128 v[64:67], v12 offset:12288
  ds_read_b128 v[68:71], v12 offset:13312
  ds_read_b128 v[72:75], v12 offset:14336
  ds_read_b128 v[76:79], v12 offset:15360
  s_add_u32 s57, s7, 1
  v_mov_b32 v7, s57
  s_waitcnt lgkmcnt(0)
  ds_write_b32 v15, v7
  s_add_u32 s7, s7, 3
  s_add_u32 s8, s8, 49152
  s_mov_b32 s44, s36
  s_mov_b32 s45, s37
  s_mov_b32 s46, 3981312
  s_mov_b32 s47, 0x20000
  s_mul_i32 s62, s5, 18
  s_mul_i32 s63, s9, 6
  s_add_u32 s62, s62, s63
  s_mul_i32 s62, s62, 6912
  v_and_b32 v232, 7, v0
  v_lshlrev_b32 v232, 4, v232
  v_lshrrev_b32 v233, 4, v0
  v_mul_u32_u24 v234, 6912, v233
  v_add_u32 v234, v234, v232
  v_and_b32 v233, 1, v233
  v_add_u32 v233, 4, v233
  v_mul_u32_u24 v233, 6912, v233
  v_add_u32 v233, v233, v232
  v_bfe_u32 v232, v0, 3, 1
  s_add_u32 s63, s4, 7
  s_and_b32 s63, s63, 7
  s_cmp_ge_u32 s63, 9
  s_movk_i32 s58, 1152
  s_cselect_b32 s58, 3456, s58
  s_movk_i32 s57, 3456
  s_cselect_b32 s57, 1152, s57
  v_mul_lo_u32 v235, v232, s58
  s_lshl_b32 s58, s63, 7
  s_add_u32 s57, s57, s58
  s_add_u32 s57, s57, s62
  s_cmp_ge_u32 s63, 18
  s_cselect_b32 s46, 0, s46
  v_add_u32 v236, v235, v234
  v_add_u32 v237, v235, v233
  buffer_load_dwordx4 v[240:243], v236, s[44:47], s57 offen
  buffer_load_dwordx4 v[240:243], v237, s[44:47], s57 offen
  s_add_u32 s63, s63, 8
  s_cmp_ge_u32 s63, 9
  s_movk_i32 s58, 1152
  s_cselect_b32 s58, 3456, s58
  s_movk_i32 s57, 3456
  s_cselect_b32 s57, 1152, s57
  v_mul_lo_u32 v235, v232, s58
  s_lshl_b32 s58, s63, 7
  s_add_u32 s57, s57, s58
  s_add_u32 s57, s57, s62
  s_cmp_ge_u32 s63, 18
  s_cselect_b32 s46, 0, s46
  v_add_u32 v236, v235, v234
  v_add_u32 v237, v235, v233
  buffer_load_dwordx4 v[240:243], v236, s[44:47], s57 offen
  buffer_load_dwordx4 v[240:243], v237, s[44:47], s57 offen
  s_add_u32 s63, s63, 8
  s_cmp_ge_u32 s63, 9
  s_movk_i32 s58, 1152
  s_cselect_b32 s58, 3456, s58
  s_movk_i32 s57, 3456
  s_cselect_b32 s57, 1152, s57
  v_mul_lo_u32 v235, v232, s58
  s_lshl_b32 s58, s63, 7
  s_add_u32 s57, s57, s58
  s_add_u32 s57, s57, s62
  s_cmp_ge_u32 s63, 18
  s_cselect_b32 s46, 0, s46
  v_add_u32 v236, v235, v234
  v_add_u32 v237, v235, v233
  buffer_load_dwordx4 v[240:243], v236, s[44:47], s57 offen
  buffer_load_dwordx4 v[240:243], v237, s[44:47], s57 offen
  s_add_u32 s63, s63, 8
  s_mov_b32 s44, s24
  s_mov_b32 s45, s25
  s_mov_b32 s46, 0
  s_mov_b32 s47, 0x20000
  s_lshl_b32 s57, s4, 5
  s_add_u32 s57, s57, s5
  s_mul_i32 s57, s57, 3
  s_add_u32 s57, s57, s9
  s_mul_i32 s57, s57, 6144
  v_add_u32 v12, s8, v9
  s_lshl_b32 s57, s7, 1
  s_add_u32 s57, s57, 2
  s_cmp_ge_u32 s56, s57
  s_cbranch_scc1 wl_10
  s_mov_b32 s58, 39215686
sp_11:
  ds_read_b32 v7, v10
  s_waitcnt lgkmcnt(0)
  v_readfirstlane_b32 s56, v7
  s_cmp_ge_u32 s56, s57
  s_cbranch_scc1 sp_11_ok
  s_sleep 4
  s_sub_u32 s58, s58, 1
  s_cbranch_scc0 sp_11
sp_11_ok:
wl_10:
  ds_read_b128 v[160:163], v12 offset:0
  ds_read_b128 v[164:167], v12 offset:1024
  ds_read_b128 v[168:171], v12 offset:2048
  ds_read_b128 v[172:175], v12 offset:3072
  ds_read_b128 v[176:179], v12 offset:4096
  ds_read_b128 v[180:183], v12 offset:5120
  ds_read_b128 v[184:187], v12 offset:6144
  ds_read_b128 v[188:191], v12 offset:7168
  ds_read_b128 v[192:195], v12 offset:8192
  ds_read_b128 v[196:199], v12 offset:9216
  ds_read_b128 v[200:203], v12 offset:10240
  ds_read_b128 v[204:207], v12 offset:11264
  s_waitcnt lgkmcnt(8)
  ds_read_b128 v[208:211], v12 offset:12288
  ds_read_b128 v[212:215], v12 offset:13312
  ds_read_b128 v[216:219], v12 offset:14336
  ds_read_b128 v[220:223], v12 offset:15360
  s_add_u32 s57, s7, 1
  v_mov_b32 v7, s57
  s_waitcnt lgkmcnt(0)
  ds_write_b32 v15, v7
  s_add_u32 s7, s7, 3
  s_add_u32 s8, s8, 49152
  s_waitcnt vmcnt(0)
  v_mov_b32 v96, 0
  v_mov_b32 v97, 0
  v_mov_b32 v98, 0
  v_mov_b32 v99, 0
  v_mov_b32 v100, 0
  v_mov_b32 v101, 0
  v_mov_b32 v102, 0
  v_mov_b32 v103, 0
  s_mov_b32 s7, s9
  s_lshl_b32 s8, s9, 14
  s_mov_b32 s59, 9
  s_mov_b32 s50, 0
  s_mov_b32 s46, 0
  s_mov_b32 s1, 1
  v_mov_b32 v229, 0
  s_branch L_noK
L_warm:
  s_mov_b32 s50, 1064960
  s_mov_b32 s46, 2
  v_mov_b32 v229, 1
  v_mov_b32 v5, 0xff800000
  v_mov_b32 v232, 0xff80ff80
  v_mov_b32 v233, 0xff80ff80
  v_mov_b32 v234, 0xff80ff80
  v_mov_b32 v235, 0xff80ff80
  v_mov_b32 v236, 0xff80ff80
  v_mov_b32 v237, 0xff80ff80
  v_mov_b32 v238, 0xff80ff80
  v_mov_b32 v239, 0xff80ff80
  v_mov_b32 v240, 0xff80ff80
  v_mov_b32 v241, 0xff80ff80
  v_mov_b32 v242, 0xff80ff80
  v_mov_b32 v243, 0xff80ff80
  v_mov_b32 v244, 0xff80ff80
  v_mov_b32 v245, 0xff80ff80
  v_mov_b32 v246, 0xff80ff80
  v_mov_b32 v247, 0xff80ff80
  v_mov_b32 v248, 0xff80ff80
  v_mov_b32 v249, 0xff80ff80
  v_mov_b32 v250, 0xff80ff80
  v_mov_b32 v251, 0xff80ff80
  v_mov_b32 v252, 0xff80ff80
  v_mov_b32 v253, 0xff80ff80
  s_mov_b32 s59, 2
  v_and_b32 v11, 7, v0
  v_lshlrev_b32 v11, 2, v11
  s_mov_b32 s10, 15
  s_mov_b32 s11, 0
fl_12:
  buffer_load_dword v12, v11, s[52:55], 0 offen sc1
  s_waitcnt vmcnt(0)
  v_cmp_eq_u32 vcc, 0, v12
  s_and_b64 vcc, vcc, s[10:11]
  s_cbranch_scc0 fle_13
  s_sleep 8
  s_sub_u32 s15, s15, 1
  s_cbranch_scc0 fl_12
  s_mov_b32 s15, 0
fle_13:
po_14:
  buffer_load_dwordx4 v[96:99], v2, s[48:51], s6 offen sc1
  s_waitcnt vmcnt(0)
  v_max3_u32 v11, v96, v97, v98
  v_max_u32 v11, v11, v99
  v_cmp_eq_u32 vcc, -1, v11
  s_cbranch_vccz poe_15
  s_sleep 2
  s_sub_u32 s15, s15, 1
  s_cbranch_scc0 po_14
  s_mov_b32 s15, 0
poe_15:
  v_and_b32 v3, 2, v0
  v_cmp_eq_u32 vcc, 0, v3
  v_mov_b32 v100, v96
  v_mov_b32 v101, v97
  v_mov_b32 v102, v98
  v_mov_b32 v103, v99
  s_mov_b64 exec, vcc
  v_mov_b32 v100, 0
  v_mov_b32 v101, 0
  v_mov_b32 v102, 0
  v_mov_b32 v103, 0
  s_not_b64 exec, vcc
  v_mov_b32 v96, 0
  v_mov_b32 v97, 0
  v_mov_b32 v98, 0
  v_mov_b32 v99, 0
  s_mov_b64 exec, -1
  s_mov_b32 s10, 0x00030003
  s_mov_b32 s11, 0x00030003
  s_branch L_noK
L_kstep:
  v_add_u32 v12, s8, v9
  s_lshl_b32 s57, s7, 1
  s_add_u32 s57, s57, 2
  s_cmp_ge_u32 s56, s57
  s_cbranch_scc1 wl_16
  s_mov_b32 s58, 83333333
sp_17:
  ds_read_b32 v7, v10
  s_waitcnt lgkmcnt(0)
  v_readfirstlane_b32 s56, v7
  s_cmp_ge_u32 s56, s57
  s_cbranch_scc1 sp_17_ok
  s_sleep 1
  s_sub_u32 s58, s58, 1
  s_cbranch_scc0 sp_17
sp_17_ok:
wl_16:
  ds_read_b128 v[16:19], v12 offset:0
  ds_read_b128 v[20:23], v12 offset:1024
  ds_read_b128 v[24:27], v12 offset:2048
  ds_read_b128 v[28:31], v12 offset:3072
  ds_read_b128 v[32:35], v12 offset:4096
  ds_read_b128 v[36:39], v12 offset:5120
  ds_read_b128 v[40:43], v12 offset:6144
  ds_read_b128 v[44:47], v12 offset:7168
  ds_read_b128 v[48:51], v12 offset:8192
  ds_read_b128 v[52:55], v12 offset:9216
  ds_read_b128 v[56:59], v12 offset:10240
  ds_read_b128 v[60:63], v12 offset:11264
  s_waitcnt lgkmcnt(8)
  ds_read_b128 v[64:67], v12 offset:12288
  ds_read_b128 v[68:71], v12 offset:13312
  ds_read_b128 v[72:75], v12 offset:14336
  ds_read_b128 v[76:79], v12 offset:15360
  s_add_u32 s57, s7, 1
  v_mov_b32 v7, s57
  s_waitcnt lgkmcnt(0)
  ds_write_b32 v15, v7
L_noK:
  v_mfma_f32_16x16x32_bf16 v[80:83], v[16:19], v[96:99], 0
  v_mfma_f32_16x16x32_bf16 v[80:83], v[20:23], v[100:103], v[80:83]
  v_mfma_f32_16x16x32_bf16 v[84:87], v[24:27], v[96:99], 0
  v_mfma_f32_16x16x32_bf16 v[84:87], v[28:31], v[100:103], v[84:87]
  v_mfma_f32_16x16x32_bf16 v[88:91], v[32:35], v[96:99], 0
  v_mfma_f32_16x16x32_bf16 v[88:91], v[36:39], v[100:103], v[88:91]
  v_mfma_f32_16x16x32_bf16 v[92:95], v[40:43], v[96:99], 0
  v_mfma_f32_16x16x32_bf16 v[92:95], v[44:47], v[100:103], v[92:95]
  v_mfma_f32_16x16x32_bf16 v[112:115], v[48:51], v[96:99], 0
  v_mfma_f32_16x16x32_bf16 v[112:115], v[52:55], v[100:103], v[112:115]
  v_mfma_f32_16x16x32_bf16 v[116:119], v[56:59], v[96:99], 0
  v_mfma_f32_16x16x32_bf16 v[116:119], v[60:63], v[100:103], v[116:119]
  v_mfma_f32_16x16x32_bf16 v[120:123], v[64:67], v[96:99], 0
  v_mfma_f32_16x16x32_bf16 v[120:123], v[68:71], v[100:103], v[120:123]
  v_mfma_f32_16x16x32_bf16 v[124:127], v[72:75], v[96:99], 0
  v_mfma_f32_16x16x32_bf16 v[124:127], v[76:79], v[100:103], v[124:127]
  v_mov_b32 v4, v80 quad_perm:[0,1,2,3] row_mask:0xf bank_mask:0x1
  v_add_f32 v4, v81, v4 row_ror:12 row_mask:0xf bank_mask:0x1
  v_add_f32 v4, v82, v4 row_ror:8 row_mask:0xf bank_mask:0x1
  v_add_f32 v4, v83, v4 row_ror:4 row_mask:0xf bank_mask:0x1
  v_mov_b32 v4, v85 quad_perm:[0,1,2,3] row_mask:0xf bank_mask:0x2
  v_add_f32 v4, v84, v4 row_ror:4 row_mask:0xf bank_mask:0x2
  v_add_f32 v4, v86, v4 row_ror:12 row_mask:0xf bank_mask:0x2
  v_add_f32 v4, v87, v4 row_ror:8 row_mask:0xf bank_mask:0x2
  v_mov_b32 v4, v90 quad_perm:[0,1,2,3] row_mask:0xf bank_mask:0x4
  v_add_f32 v4, v88, v4 row_ror:8 row_mask:0xf bank_mask:0x4
  v_add_f32 v4, v89, v4 row_ror:4 row_mask:0xf bank_mask:0x4
  v_add_f32 v4, v91, v4 row_ror:12 row_mask:0xf bank_mask:0x4
  v_mov_b32 v4, v95 quad_perm:[0,1,2,3] row_mask:0xf bank_mask:0x8
  v_add_f32 v4, v92, v4 row_ror:12 row_mask:0xf bank_mask:0x8
  v_add_f32 v4, v93, v4 row_ror:8 row_mask:0xf bank_mask:0x8
  v_add_f32 v4, v94, v4 row_ror:4 row_mask:0xf bank_mask:0x8
  v_mov_b32 v8, v112 quad_perm:[0,1,2,3] row_mask:0xf bank_mask:0x1
  v_add_f32 v8, v113, v8 row_ror:12 row_mask:0xf bank_mask:0x1
  v_add_f32 v8, v114, v8 row_ror:8 row_mask:0xf bank_mask:0x1
  v_add_f32 v8, v115, v8 row_ror:4 row_mask:0xf bank_mask:0x1
  v_mov_b32 v8, v117 quad_perm:[0,1,2,3] row_mask:0xf bank_mask:0x2
  v_add_f32 v8, v116, v8 row_ror:4 row_mask:0xf bank_mask:0x2
  v_add_f32 v8, v118, v8 row_ror:12 row_mask:0xf bank_mask:0x2
  v_add_f32 v8, v119, v8 row_ror:8 row_mask:0xf bank_mask:0x2
  v_mov_b32 v8, v122 quad_perm:[0,1,2,3] row_mask:0xf bank_mask:0x4
  v_add_f32 v8, v120, v8 row_ror:8 row_mask:0xf bank_mask:0x4
  v_add_f32 v8, v121, v8 row_ror:4 row_mask:0xf bank_mask:0x4
  v_add_f32 v8, v123, v8 row_ror:12 row_mask:0xf bank_mask:0x4
  v_mov_b32 v8, v127 quad_perm:[0,1,2,3] row_mask:0xf bank_mask:0x8
  v_add_f32 v8, v124, v8 row_ror:12 row_mask:0xf bank_mask:0x8
  v_add_f32 v8, v125, v8 row_ror:8 row_mask:0xf bank_mask:0x8
  v_add_f32 v8, v126, v8 row_ror:4 row_mask:0xf bank_mask:0x8
  v_mov_b32 v253, v252
  v_mov_b32 v252, v251
  v_mov_b32 v251, v250
  v_mov_b32 v250, v249
  v_mov_b32 v249, v248
  v_mov_b32 v248, v247
  v_mov_b32 v247, v246
  v_mov_b32 v246, v245
  v_mov_b32 v245, v244
  v_mov_b32 v244, v243
  v_mov_b32 v243, v242
  v_mov_b32 v242, v241
  v_mov_b32 v241, v240
  v_mov_b32 v240, v239
  v_mov_b32 v239, v238
  v_mov_b32 v238, v237
  v_mov_b32 v237, v236
  v_mov_b32 v236, v235
  v_mov_b32 v235, v234
  v_mov_b32 v234, v233
  v_mov_b32 v233, v232
  v_cvt_pk_bf16_f32 v7, v4, v8
  v_lshlrev_b32 v4, 16, v7
  v_and_b32 v8, 0xffff0000, v7
  v_mul_f32 v4, 0x3db504f3, v4
  v_mul_f32 v8, 0x3db504f3, v8
  v_cvt_pk_bf16_f32 v232, v4, v8
  v_lshlrev_b32 v4, 16, v232
  v_and_b32 v8, 0xffff0000, v232
  v_max3_f32 v5, v5, v4, v8
  s_cmp_eq_u32 s59, 0
  s_cbranch_scc0 L_special
L_knext:
  s_add_u32 s7, s7, 3
  s_add_u32 s8, s8, 49152
  s_cmp_ge_u32 s8, 147456
  s_cselect_b32 s57, 147456, 0
  s_sub_u32 s8, s8, s57
  s_cmp_lt_u32 s7, 64
  s_cbranch_scc1 L_kstep
  s_cmp_eq_u32 s9, 0
  s_cbranch_scc1 L_sw22
  v_mov_b32 v253, v252
  v_mov_b32 v252, v251
  v_mov_b32 v251, v250
  v_mov_b32 v250, v249
  v_mov_b32 v249, v248
  v_mov_b32 v248, v247
  v_mov_b32 v247, v246
  v_mov_b32 v246, v245
  v_mov_b32 v245, v244
  v_mov_b32 v244, v243
  v_mov_b32 v243, v242
  v_mov_b32 v242, v241
  v_mov_b32 v241, v240
  v_mov_b32 v240, v239
  v_mov_b32 v239, v238
  v_mov_b32 v238, v237
  v_mov_b32 v237, v236
  v_mov_b32 v236, v235
  v_mov_b32 v235, v234
  v_mov_b32 v234, v233
  v_mov_b32 v233, v232
  v_mov_b32 v232, 0xff80ff80
L_sw22:
  s_nop 1
  v_max_f32 v5, v5, v5 quad_perm:[2,3,0,1] row_mask:0xf bank_mask:0xf
  s_nop 1
  v_max_f32 v5, v5, v5 row_ror:4 row_mask:0xf bank_mask:0xf
  s_nop 1
  v_max_f32 v5, v5, v5 row_ror:8 row_mask:0xf bank_mask:0xf
  v_mov_b32 v7, v5
  s_nop 1
  v_permlane16_swap_b32 v5, v7
  v_max_f32 v5, v5, v7
  v_mov_b32 v7, v5
  s_nop 1
  v_permlane32_swap_b32 v5, v7
  v_max_f32 v5, v5, v7
  v_mov_b32 v6, 0
  v_lshlrev_b32 v16, 16, v232
  v_and_b32 v17, 0xffff0000, v232
  v_lshlrev_b32 v18, 16, v233
  v_and_b32 v19, 0xffff0000, v233
  v_lshlrev_b32 v20, 16, v234
  v_and_b32 v21, 0xffff0000, v234
  v_lshlrev_b32 v22, 16, v235
  v_and_b32 v23, 0xffff0000, v235
  v_lshlrev_b32 v24, 16, v236
  v_and_b32 v25, 0xffff0000, v236
  v_lshlrev_b32 v26, 16, v237
  v_and_b32 v27, 0xffff0000, v237
  v_lshlrev_b32 v28, 16, v238
  v_and_b32 v29, 0xffff0000, v238
  v_lshlrev_b32 v30, 16, v239
  v_and_b32 v31, 0xffff0000, v239
  v_sub_f32 v16, v16, v5
  v_sub_f32 v17, v17, v5
  v_sub_f32 v18, v18, v5
  v_sub_f32 v19, v19, v5
  v_sub_f32 v20, v20, v5
  v_sub_f32 v21, v21, v5
  v_sub_f32 v22, v22, v5
  v_sub_f32 v23, v23, v5
  v_sub_f32 v24, v24, v5
  v_sub_f32 v25, v25, v5
  v_sub_f32 v26, v26, v5
  v_sub_f32 v27, v27, v5
  v_sub_f32 v28, v28, v5
  v_sub_f32 v29, v29, v5
  v_sub_f32 v30, v30, v5
  v_sub_f32 v31, v31, v5
  v_mul_f32 v16, 0x3fb8aa3b, v16
  v_mul_f32 v17, 0x3fb8aa3b, v17
  v_mul_f32 v18, 0x3fb8aa3b, v18
  v_mul_f32 v19, 0x3fb8aa3b, v19
  v_mul_f32 v20, 0x3fb8aa3b, v20
  v_mul_f32 v21, 0x3fb8aa3b, v21
  v_mul_f32 v22, 0x3fb8aa3b, v22
  v_mul_f32 v23, 0x3fb8aa3b, v23
  v_mul_f32 v24, 0x3fb8aa3b, v24
  v_mul_f32 v25, 0x3fb8aa3b, v25
  v_mul_f32 v26, 0x3fb8aa3b, v26
  v_mul_f32 v27, 0x3fb8aa3b, v27
  v_mul_f32 v28, 0x3fb8aa3b, v28
  v_mul_f32 v29, 0x3fb8aa3b, v29
  v_mul_f32 v30, 0x3fb8aa3b, v30
  v_mul_f32 v31, 0x3fb8aa3b, v31
  v_exp_f32 v16, v16
  v_exp_f32 v17, v17
  v_exp_f32 v18, v18
  v_exp_f32 v19, v19
  v_exp_f32 v20, v20
  v_exp_f32 v21, v21
  v_exp_f32 v22, v22
  v_exp_f32 v23, v23
  v_exp_f32 v24, v24
  v_exp_f32 v25, v25
  v_exp_f32 v26, v26
  v_exp_f32 v27, v27
  v_exp_f32 v28, v28
  v_exp_f32 v29, v29
  v_exp_f32 v30, v30
  v_exp_f32 v31, v31
  v_add_f32 v6, v6, v16
  v_add_f32 v6, v6, v17
  v_add_f32 v6, v6, v18
  v_add_f32 v6, v6, v19
  v_add_f32 v6, v6, v20
  v_add_f32 v6, v6, v21
  v_add_f32 v6, v6, v22
  v_add_f32 v6, v6, v23
  v_add_f32 v6, v6, v24
  v_add_f32 v6, v6, v25
  v_add_f32 v6, v6, v26
  v_add_f32 v6, v6, v27
  v_add_f32 v6, v6, v28
  v_add_f32 v6, v6, v29
  v_add_f32 v6, v6, v30
  v_add_f32 v6, v6, v31
  v_lshlrev_b32 v16, 16, v240
  v_and_b32 v17, 0xffff0000, v240
  v_lshlrev_b32 v18, 16, v241
  v_and_b32 v19, 0xffff0000, v241
  v_lshlrev_b32 v20, 16, v242
  v_and_b32 v21, 0xffff0000, v242
  v_lshlrev_b32 v22, 16, v243
  v_and_b32 v23, 0xffff0000, v243
  v_lshlrev_b32 v24, 16, v244
  v_and_b32 v25, 0xffff0000, v244
  v_lshlrev_b32 v26, 16, v245
  v_and_b32 v27, 0xffff0000, v245
  v_lshlrev_b32 v28, 16, v246
  v_and_b32 v29, 0xffff0000, v246
  v_lshlrev_b32 v30, 16, v247
  v_and_b32 v31, 0xffff0000, v247
  v_sub_f32 v16, v16, v5
  v_sub_f32 v17, v17, v5
  v_sub_f32 v18, v18, v5
  v_sub_f32 v19, v19, v5
  v_sub_f32 v20, v20, v5
  v_sub_f32 v21, v21, v5
  v_sub_f32 v22, v22, v5
  v_sub_f32 v23, v23, v5
  v_sub_f32 v24, v24, v5
  v_sub_f32 v25, v25, v5
  v_sub_f32 v26, v26, v5
  v_sub_f32 v27, v27, v5
  v_sub_f32 v28, v28, v5
  v_sub_f32 v29, v29, v5
  v_sub_f32 v30, v30, v5
  v_sub_f32 v31, v31, v5
  v_mul_f32 v16, 0x3fb8aa3b, v16
  v_mul_f32 v17, 0x3fb8aa3b, v17
  v_mul_f32 v18, 0x3fb8aa3b, v18
  v_mul_f32 v19, 0x3fb8aa3b, v19
  v_mul_f32 v20, 0x3fb8aa3b, v20
  v_mul_f32 v21, 0x3fb8aa3b, v21
  v_mul_f32 v22, 0x3fb8aa3b, v22
  v_mul_f32 v23, 0x3fb8aa3b, v23
  v_mul_f32 v24, 0x3fb8aa3b, v24
  v_mul_f32 v25, 0x3fb8aa3b, v25
  v_mul_f32 v26, 0x3fb8aa3b, v26
  v_mul_f32 v27, 0x3fb8aa3b, v27
  v_mul_f32 v28, 0x3fb8aa3b, v28
  v_mul_f32 v29, 0x3fb8aa3b, v29
  v_mul_f32 v30, 0x3fb8aa3b, v30
  v_mul_f32 v31, 0x3fb8aa3b, v31
  v_exp_f32 v16, v16
  v_exp_f32 v17, v17
  v_exp_f32 v18, v18
  v_exp_f32 v19, v19
  v_exp_f32 v20, v20
  v_exp_f32 v21, v21
  v_exp_f32 v22, v22
  v_exp_f32 v23, v23
  v_exp_f32 v24, v24
  v_exp_f32 v25, v25
  v_exp_f32 v26, v26
  v_exp_f32 v27, v27
  v_exp_f32 v28, v28
  v_exp_f32 v29, v29
  v_exp_f32 v30, v30
  v_exp_f32 v31, v31
  v_add_f32 v6, v6, v16
  v_add_f32 v6, v6, v17
  v_add_f32 v6, v6, v18
  v_add_f32 v6, v6, v19
  v_add_f32 v6, v6, v20
  v_add_f32 v6, v6, v21
  v_add_f32 v6, v6, v22
  v_add_f32 v6, v6, v23
  v_add_f32 v6, v6, v24
  v_add_f32 v6, v6, v25
  v_add_f32 v6, v6, v26
  v_add_f32 v6, v6, v27
  v_add_f32 v6, v6, v28
  v_add_f32 v6, v6, v29
  v_add_f32 v6, v6, v30
  v_add_f32 v6, v6, v31
  v_lshlrev_b32 v16, 16, v248
  v_and_b32 v17, 0xffff0000, v248
  v_lshlrev_b32 v18, 16, v249
  v_and_b32 v19, 0xffff0000, v249
  v_lshlrev_b32 v20, 16, v250
  v_and_b32 v21, 0xffff0000, v250
  v_lshlrev_b32 v22, 16, v251
  v_and_b32 v23, 0xffff0000, v251
  v_lshlrev_b32 v24, 16, v252
  v_and_b32 v25, 0xffff0000, v252
  v_lshlrev_b32 v26, 16, v253
  v_and_b32 v27, 0xffff0000, v253
  v_sub_f32 v16, v16, v5
  v_sub_f32 v17, v17, v5
  v_sub_f32 v18, v18, v5
  v_sub_f32 v19, v19, v5
  v_sub_f32 v20, v20, v5
  v_sub_f32 v21, v21, v5
  v_sub_f32 v22, v22, v5
  v_sub_f32 v23, v23, v5
  v_sub_f32 v24, v24, v5
  v_sub_f32 v25, v25, v5
  v_sub_f32 v26, v26, v5
  v_sub_f32 v27, v27, v5
  v_mul_f32 v16, 0x3fb8aa3b, v16
  v_mul_f32 v17, 0x3fb8aa3b, v17
  v_mul_f32 v18, 0x3fb8aa3b, v18
  v_mul_f32 v19, 0x3fb8aa3b, v19
  v_mul_f32 v20, 0x3fb8aa3b, v20
  v_mul_f32 v21, 0x3fb8aa3b, v21
  v_mul_f32 v22, 0x3fb8aa3b, v22
  v_mul_f32 v23, 0x3fb8aa3b, v23
  v_mul_f32 v24, 0x3fb8aa3b, v24
  v_mul_f32 v25, 0x3fb8aa3b, v25
  v_mul_f32 v26, 0x3fb8aa3b, v26
  v_mul_f32 v27, 0x3fb8aa3b, v27
  v_exp_f32 v16, v16
  v_exp_f32 v17, v17
  v_exp_f32 v18, v18
  v_exp_f32 v19, v19
  v_exp_f32 v20, v20
  v_exp_f32 v21, v21
  v_exp_f32 v22, v22
  v_exp_f32 v23, v23
  v_exp_f32 v24, v24
  v_exp_f32 v25, v25
  v_exp_f32 v26, v26
  v_exp_f32 v27, v27
  v_add_f32 v6, v6, v16
  v_add_f32 v6, v6, v17
  v_add_f32 v6, v6, v18
  v_add_f32 v6, v6, v19
  v_add_f32 v6, v6, v20
  v_add_f32 v6, v6, v21
  v_add_f32 v6, v6, v22
  v_add_f32 v6, v6, v23
  v_add_f32 v6, v6, v24
  v_add_f32 v6, v6, v25
  v_add_f32 v6, v6, v26
  v_add_f32 v6, v6, v27
  s_nop 1
  v_add_f32 v6, v6, v6 quad_perm:[2,3,0,1] row_mask:0xf bank_mask:0xf
  s_nop 1
  v_add_f32 v6, v6, v6 row_ror:4 row_mask:0xf bank_mask:0xf
  s_nop 1
  v_add_f32 v6, v6, v6 row_ror:8 row_mask:0xf bank_mask:0xf
  v_mov_b32 v7, v6
  s_nop 1
  v_permlane16_swap_b32 v6, v7
  v_add_f32 v6, v6, v7
  v_mov_b32 v7, v6
  s_nop 1
  v_permlane32_swap_b32 v6, v7
  v_add_f32 v6, v6, v7
  v_and_b32 v11, 7, v0
  v_lshlrev_b32 v11, 2, v11
  s_mov_b32 s10, 31
  s_mov_b32 s11, 0
fl_18:
  buffer_load_dword v12, v11, s[52:55], 0 offen sc1
  s_waitcnt vmcnt(0)
  v_cmp_eq_u32 vcc, 0, v12
  s_and_b64 vcc, vcc, s[10:11]
  s_cbranch_scc0 fle_19
  s_sleep 8
  s_sub_u32 s15, s15, 1
  s_cbranch_scc0 fl_18
  s_mov_b32 s15, 0
fle_19:
  s_mov_b32 s10, 0x00030003
  s_mov_b32 s11, 0x00030003
  v_mov_b32 v80, v5
  v_mov_b32 v81, v6
  s_lshl_b32 s57, s9, 3
  s_add_u32 s57, s57, s0
  s_mov_b64 exec, 3
  buffer_store_dwordx2 v[80:81], v227, s[48:51], s57 offen sc1
  s_mov_b64 exec, -1
  s_add_u32 s7, s9, 64
  s_add_u32 s8, s9, 1
  s_lshl_b32 s8, s8, 14
  v_mov_b32 v128, 0
  v_mov_b32 v160, 0
  v_mov_b32 v192, 0
  v_mov_b32 v129, 0
  v_mov_b32 v161, 0
  v_mov_b32 v193, 0
  v_mov_b32 v130, 0
  v_mov_b32 v162, 0
  v_mov_b32 v194, 0
  v_mov_b32 v131, 0
  v_mov_b32 v163, 0
  v_mov_b32 v195, 0
L_vstep:
  v_add_u32 v12, s8, v9
  v_lshlrev_b32 v4, 16, v253
  v_and_b32 v8, 0xffff0000, v253
  v_sub_f32 v4, v4, v5
  v_sub_f32 v8, v8, v5
  v_mul_f32 v4, 0x3fb8aa3b, v4
  v_mul_f32 v8, 0x3fb8aa3b, v8
  v_exp_f32 v4, v4
  v_exp_f32 v8, v8
  v_mov_b32 v253, v252
  v_mov_b32 v252, v251
  v_mov_b32 v251, v250
  v_mov_b32 v250, v249
  v_mov_b32 v249, v248
  v_mov_b32 v248, v247
  v_mov_b32 v247, v246
  v_mov_b32 v246, v245
  v_mov_b32 v245, v244
  v_mov_b32 v244, v243
  v_mov_b32 v243, v242
  v_mov_b32 v242, v241
  v_mov_b32 v241, v240
  v_mov_b32 v240, v239
  v_mov_b32 v239, v238
  v_mov_b32 v238, v237
  v_mov_b32 v237, v236
  v_mov_b32 v236, v235
  v_mov_b32 v235, v234
  v_mov_b32 v234, v233
  v_mov_b32 v233, v232
  v_mov_b32 v80, v4 quad_perm:[2,3,2,3] row_mask:0xf bank_mask:0xf
  v_mov_b32 v81, v8 quad_perm:[2,3,2,3] row_mask:0xf bank_mask:0xf
  v_cvt_pk_bf16_f32 v104, v4, v80
  v_cvt_pk_bf16_f32 v108, v8, v81
  s_cmp_eq_u32 s7, s97
  s_nop 0
  v_mov_b32 v105, v104 row_ror:12 row_mask:0xf bank_mask:0xf
  v_mov_b32 v109, v108 row_ror:12 row_mask:0xf bank_mask:0xf
  v_mov_b32 v106, v104 row_ror:8 row_mask:0xf bank_mask:0xf
  v_mov_b32 v110, v108 row_ror:8 row_mask:0xf bank_mask:0xf
  v_mov_b32 v107, v104 row_ror:4 row_mask:0xf bank_mask:0xf
  v_mov_b32 v111, v108 row_ror:4 row_mask:0xf bank_mask:0xf
  s_mov_b64 exec, s[10:11]
  v_mov_b32 v160, v104
  v_mov_b32 v161, v105
  v_mov_b32 v162, v106
  v_mov_b32 v163, v107
  v_mov_b32 v192, v108
  v_mov_b32 v193, v109
  v_mov_b32 v194, v110
  v_mov_b32 v195, v111
  s_mov_b64 exec, -1
  v_mov_b32 v164, v160 row_ror:2 row_mask:0xf bank_mask:0xf
  v_mov_b32 v165, v161 row_ror:2 row_mask:0xf bank_mask:0xf
  v_mov_b32 v166, v162 row_ror:2 row_mask:0xf bank_mask:0xf
  v_mov_b32 v167, v163 row_ror:2 row_mask:0xf bank_mask:0xf
  v_mov_b32 v168, v160 row_ror:4 row_mask:0xf bank_mask:0xf
  v_mov_b32 v169, v161 row_ror:4 row_mask:0xf bank_mask:0xf
  v_mov_b32 v170, v162 row_ror:4 row_mask:0xf bank_mask:0xf
  v_mov_b32 v171, v163 row_ror:4 row_mask:0xf bank_mask:0xf
  v_mov_b32 v172, v160 row_ror:6 row_mask:0xf bank_mask:0xf
  v_mov_b32 v173, v161 row_ror:6 row_mask:0xf bank_mask:0xf
  v_mov_b32 v174, v162 row_ror:6 row_mask:0xf bank_mask:0xf
  v_mov_b32 v175, v163 row_ror:6 row_mask:0xf bank_mask:0xf
  v_mov_b32 v176, v160 row_ror:8 row_mask:0xf bank_mask:0xf
  v_mov_b32 v177, v161 row_ror:8 row_mask:0xf bank_mask:0xf
  v_mov_b32 v178, v162 row_ror:8 row_mask:0xf bank_mask:0xf
  v_mov_b32 v179, v163 row_ror:8 row_mask:0xf bank_mask:0xf
  v_mov_b32 v180, v160 row_ror:10 row_mask:0xf bank_mask:0xf
  v_mov_b32 v181, v161 row_ror:10 row_mask:0xf bank_mask:0xf
  v_mov_b32 v182, v162 row_ror:10 row_mask:0xf bank_mask:0xf
  v_mov_b32 v183, v163 row_ror:10 row_mask:0xf bank_mask:0xf
  v_mov_b32 v184, v160 row_ror:12 row_mask:0xf bank_mask:0xf
  v_mov_b32 v185, v161 row_ror:12 row_mask:0xf bank_mask:0xf
  v_mov_b32 v186, v162 row_ror:12 row_mask:0xf bank_mask:0xf
  v_mov_b32 v187, v163 row_ror:12 row_mask:0xf bank_mask:0xf
  v_mov_b32 v188, v160 row_ror:14 row_mask:0xf bank_mask:0xf
  v_mov_b32 v189, v161 row_ror:14 row_mask:0xf bank_mask:0xf
  v_mov_b32 v190, v162 row_ror:14 row_mask:0xf bank_mask:0xf
  v_mov_b32 v191, v163 row_ror:14 row_mask:0xf bank_mask:0xf
  v_mov_b32 v196, v192 row_ror:2 row_mask:0xf bank_mask:0xf
  v_mov_b32 v197, v193 row_ror:2 row_mask:0xf bank_mask:0xf
  v_mov_b32 v198, v194 row_ror:2 row_mask:0xf bank_mask:0xf
  v_mov_b32 v199, v195 row_ror:2 row_mask:0xf bank_mask:0xf
  v_mov_b32 v200, v192 row_ror:4 row_mask:0xf bank_mask:0xf
  v_mov_b32 v201, v193 row_ror:4 row_mask:0xf bank_mask:0xf
  v_mov_b32 v202, v194 row_ror:4 row_mask:0xf bank_mask:0xf
  v_mov_b32 v203, v195 row_ror:4 row_mask:0xf bank_mask:0xf
  v_mov_b32 v204, v192 row_ror:6 row_mask:0xf bank_mask:0xf
  v_mov_b32 v205, v193 row_ror:6 row_mask:0xf bank_mask:0xf
  v_mov_b32 v206, v194 row_ror:6 row_mask:0xf bank_mask:0xf
  v_mov_b32 v207, v195 row_ror:6 row_mask:0xf bank_mask:0xf
  v_mov_b32 v208, v192 row_ror:8 row_mask:0xf bank_mask:0xf
  v_mov_b32 v209, v193 row_ror:8 row_mask:0xf bank_mask:0xf
  v_mov_b32 v210, v194 row_ror:8 row_mask:0xf bank_mask:0xf
  v_mov_b32 v211, v195 row_ror:8 row_mask:0xf bank_mask:0xf
  v_mov_b32 v212, v192 row_ror:10 row_mask:0xf bank_mask:0xf
  v_mov_b32 v213, v193 row_ror:10 row_mask:0xf bank_mask:0xf
  v_mov_b32 v214, v194 row_ror:10 row_mask:0xf bank_mask:0xf
  v_mov_b32 v215, v195 row_ror:10 row_mask:0xf bank_mask:0xf
  v_mov_b32 v216, v192 row_ror:12 row_mask:0xf bank_mask:0xf
  v_mov_b32 v217, v193 row_ror:12 row_mask:0xf bank_mask:0xf
  v_mov_b32 v218, v194 row_ror:12 row_mask:0xf bank_mask:0xf
  v_mov_b32 v219, v195 row_ror:12 row_mask:0xf bank_mask:0xf
  v_mov_b32 v220, v192 row_ror:14 row_mask:0xf bank_mask:0xf
  v_mov_b32 v221, v193 row_ror:14 row_mask:0xf bank_mask:0xf
  v_mov_b32 v222, v194 row_ror:14 row_mask:0xf bank_mask:0xf
  v_mov_b32 v223, v195 row_ror:14 row_mask:0xf bank_mask:0xf
  s_cbranch_scc1 L_fact
L_fact_r:
  s_lshl_b32 s57, s7, 1
  s_add_u32 s57, s57, 1
  s_cmp_ge_u32 s56, s57
  s_cbranch_scc1 wl_20
  s_mov_b32 s58, 83333333
sp_21:
  ds_read_b32 v7, v10
  s_waitcnt lgkmcnt(0)
  v_readfirstlane_b32 s56, v7
  s_cmp_ge_u32 s56, s57
  s_cbranch_scc1 sp_21_ok
  s_sleep 1
  s_sub_u32 s58, s58, 1
  s_cbranch_scc0 sp_21
sp_21_ok:
wl_20:
  ds_read_b128 v[16:19], v12 offset:0
  ds_read_b128 v[20:23], v12 offset:1024
  ds_read_b128 v[24:27], v12 offset:2048
  ds_read_b128 v[28:31], v12 offset:3072
  ds_read_b128 v[32:35], v12 offset:4096
  ds_read_b128 v[36:39], v12 offset:5120
  ds_read_b128 v[40:43], v12 offset:6144
  ds_read_b128 v[44:47], v12 offset:7168
  ds_read_b32 v7, v10
  s_add_u32 s57, s57, 1
  s_waitcnt lgkmcnt(0)
  v_readfirstlane_b32 s56, v7
  s_cmp_ge_u32 s56, s57
  s_cbranch_scc0 L_vA
  ds_read_b128 v[48:51], v12 offset:8192
  ds_read_b128 v[52:55], v12 offset:9216
  ds_read_b128 v[56:59], v12 offset:10240
  ds_read_b128 v[60:63], v12 offset:11264
  ds_read_b128 v[64:67], v12 offset:12288
  ds_read_b128 v[68:71], v12 offset:13312
  ds_read_b128 v[72:75], v12 offset:14336
  ds_read_b128 v[76:79], v12 offset:15360
L_vA:
  v_perm_b32 v112, v20, v16, s60
  v_perm_b32 v113, v28, v24, s60
  v_perm_b32 v114, v36, v32, s60
  v_perm_b32 v115, v44, v40, s60
  v_perm_b32 v116, v20, v16, s61
  v_perm_b32 v117, v28, v24, s61
  v_perm_b32 v118, v36, v32, s61
  v_perm_b32 v119, v44, v40, s61
  v_mfma_f32_16x16x32_bf16 v[128:131], v[112:115], v[160:163], v[128:131]
  v_perm_b32 v120, v21, v17, s60
  v_perm_b32 v121, v29, v25, s60
  v_perm_b32 v122, v37, v33, s60
  v_perm_b32 v123, v45, v41, s60
  v_mfma_f32_16x16x32_bf16 v[128:131], v[116:119], v[164:167], v[128:131]
  v_perm_b32 v124, v21, v17, s61
  v_perm_b32 v125, v29, v25, s61
  v_perm_b32 v126, v37, v33, s61
  v_perm_b32 v127, v45, v41, s61
  v_mfma_f32_16x16x32_bf16 v[128:131], v[120:123], v[168:171], v[128:131]
  v_perm_b32 v112, v22, v18, s60
  v_perm_b32 v113, v30, v26, s60
  v_perm_b32 v114, v38, v34, s60
  v_perm_b32 v115, v46, v42, s60
  v_mfma_f32_16x16x32_bf16 v[128:131], v[124:127], v[172:175], v[128:131]
  v_perm_b32 v116, v22, v18, s61
  v_perm_b32 v117, v30, v26, s61
  v_perm_b32 v118, v38, v34, s61
  v_perm_b32 v119, v46, v42, s61
  v_mfma_f32_16x16x32_bf16 v[128:131], v[112:115], v[176:179], v[128:131]
  v_perm_b32 v120, v23, v19, s60
  v_perm_b32 v121, v31, v27, s60
  v_perm_b32 v122, v39, v35, s60
  v_perm_b32 v123, v47, v43, s60
  v_mfma_f32_16x16x32_bf16 v[128:131], v[116:119], v[180:183], v[128:131]
  v_perm_b32 v124, v23, v19, s61
  v_perm_b32 v125, v31, v27, s61
  v_perm_b32 v126, v39, v35, s61
  v_perm_b32 v127, v47, v43, s61
  v_mfma_f32_16x16x32_bf16 v[128:131], v[120:123], v[184:187], v[128:131]
  s_nop 1
  v_mfma_f32_16x16x32_bf16 v[128:131], v[124:127], v[188:191], v[128:131]
  s_cbranch_scc1 L_vB
  s_lshl_b32 s57, s7, 1
  s_add_u32 s57, s57, 2
  s_cmp_ge_u32 s56, s57
  s_cbranch_scc1 wl_22
  s_mov_b32 s58, 133333333
sp_23:
  ds_read_b32 v7, v10
  s_waitcnt lgkmcnt(0)
  v_readfirstlane_b32 s56, v7
  s_cmp_ge_u32 s56, s57
  s_cbranch_scc1 sp_23_ok
  s_sub_u32 s58, s58, 1
  s_cbranch_scc0 sp_23
sp_23_ok:
wl_22:
  ds_read_b128 v[48:51], v12 offset:8192
  ds_read_b128 v[52:55], v12 offset:9216
  ds_read_b128 v[56:59], v12 offset:10240
  ds_read_b128 v[60:63], v12 offset:11264
  ds_read_b128 v[64:67], v12 offset:12288
  ds_read_b128 v[68:71], v12 offset:13312
  ds_read_b128 v[72:75], v12 offset:14336
  ds_read_b128 v[76:79], v12 offset:15360
L_vB:
  s_add_u32 s57, s7, 1
  v_mov_b32 v7, s57
  s_waitcnt lgkmcnt(0)
  ds_write_b32 v15, v7
  v_perm_b32 v112, v52, v48, s60
  v_perm_b32 v113, v60, v56, s60
  v_perm_b32 v114, v68, v64, s60
  v_perm_b32 v115, v76, v72, s60
  v_perm_b32 v116, v52, v48, s61
  v_perm_b32 v117, v60, v56, s61
  v_perm_b32 v118, v68, v64, s61
  v_perm_b32 v119, v76, v72, s61
  v_mfma_f32_16x16x32_bf16 v[128:131], v[112:115], v[192:195], v[128:131]
  v_perm_b32 v120, v53, v49, s60
  v_perm_b32 v121, v61, v57, s60
  v_perm_b32 v122, v69, v65, s60
  v_perm_b32 v123, v77, v73, s60
  v_mfma_f32_16x16x32_bf16 v[128:131], v[116:119], v[196:199], v[128:131]
  v_perm_b32 v124, v53, v49, s61
  v_perm_b32 v125, v61, v57, s61
  v_perm_b32 v126, v69, v65, s61
  v_perm_b32 v127, v77, v73, s61
  v_mfma_f32_16x16x32_bf16 v[128:131], v[120:123], v[200:203], v[128:131]
  v_perm_b32 v112, v54, v50, s60
  v_perm_b32 v113, v62, v58, s60
  v_perm_b32 v114, v70, v66, s60
  v_perm_b32 v115, v78, v74, s60
  v_mfma_f32_16x16x32_bf16 v[128:131], v[124:127], v[204:207], v[128:131]
  v_perm_b32 v116, v54, v50, s61
  v_perm_b32 v117, v62, v58, s61
  v_perm_b32 v118, v70, v66, s61
  v_perm_b32 v119, v78, v74, s61
  v_mfma_f32_16x16x32_bf16 v[128:131], v[112:115], v[208:211], v[128:131]
  v_perm_b32 v120, v55, v51, s60
  v_perm_b32 v121, v63, v59, s60
  v_perm_b32 v122, v71, v67, s60
  v_perm_b32 v123, v79, v75, s60
  v_mfma_f32_16x16x32_bf16 v[128:131], v[116:119], v[212:215], v[128:131]
  v_perm_b32 v124, v55, v51, s61
  v_perm_b32 v125, v63, v59, s61
  v_perm_b32 v126, v71, v67, s61
  v_perm_b32 v127, v79, v75, s61
  v_mfma_f32_16x16x32_bf16 v[128:131], v[120:123], v[216:219], v[128:131]
  s_nop 1
  v_mfma_f32_16x16x32_bf16 v[128:131], v[124:127], v[220:223], v[128:131]
  s_add_u32 s7, s7, 3
  s_add_u32 s8, s8, 49152
  s_cmp_ge_u32 s8, 147456
  s_cselect_b32 s57, 147456, 0
  s_sub_u32 s8, s8, s57
  s_cmp_lt_u32 s7, 128
  s_cbranch_scc1 L_vstep
L_cfin:
  s_nop 0
  ds_write_b128 v13, v[128:131]
  s_mov_b64 exec, 1
  ds_add_rtn_u32 v7, v228, v229
  s_mov_b64 exec, -1
  ds_read_b128 v[112:115], v224 offset:0
  ds_read_b128 v[116:119], v224 offset:1024
  ds_read_b128 v[120:123], v224 offset:2048
  s_waitcnt lgkmcnt(3)
  v_readfirstlane_b32 s57, v7
  s_cmp_lg_u32 s57, s46
  s_cbranch_scc1 L_cend
  s_waitcnt lgkmcnt(2)
  v_pk_mul_f32 v[112:113], v[112:113], v[96:97] op_sel_hi:[1,0]
  v_pk_mul_f32 v[114:115], v[114:115], v[96:97] op_sel_hi:[1,0]
  s_waitcnt lgkmcnt(1)
  v_pk_fma_f32 v[112:113], v[116:117], v[98:99], v[112:113] op_sel_hi:[1,0,1]
  v_pk_fma_f32 v[114:115], v[118:119], v[98:99], v[114:115] op_sel_hi:[1,0,1]
  s_waitcnt lgkmcnt(0)
  v_pk_fma_f32 v[112:113], v[120:121], v[100:101], v[112:113] op_sel_hi:[1,0,1]
  v_pk_fma_f32 v[114:115], v[122:123], v[100:101], v[114:115] op_sel_hi:[1,0,1]
  v_cvt_pk_bf16_f32 v80, v112, v113
  v_cvt_pk_bf16_f32 v81, v114, v115
  s_cmp_eq_u32 s1, 1
  s_cbranch_scc0 st_24_g
  buffer_store_dwordx2 v[80:81], v226, s[48:51], s96 offen
  s_branch st_24
st_24_g:
  buffer_store_dwordx2 v[80:81], v226, s[48:51], s96 offen sc1
st_24:
  ds_write_b32 v228, v229 offset:8
  s_cmp_eq_u32 s59, 9
  s_cbranch_scc1 L_warm
L_cend:
  s_endpgm
L_special:
  s_cmp_eq_u32 s59, 9
  s_cbranch_scc1 L_cfin
  s_sub_u32 s59, s59, 1
  s_cmp_eq_u32 s59, 0
  s_cbranch_scc1 L_knext
  ds_read_b32 v7, v10
  v_mov_b32 v16, v160
  v_mov_b32 v17, v161
  v_mov_b32 v18, v162
  v_mov_b32 v19, v163
  v_mov_b32 v20, v164
  v_mov_b32 v21, v165
  v_mov_b32 v22, v166
  v_mov_b32 v23, v167
  v_mov_b32 v24, v168
  v_mov_b32 v25, v169
  v_mov_b32 v26, v170
  v_mov_b32 v27, v171
  v_mov_b32 v28, v172
  v_mov_b32 v29, v173
  v_mov_b32 v30, v174
  v_mov_b32 v31, v175
  v_mov_b32 v32, v176
  v_mov_b32 v33, v177
  v_mov_b32 v34, v178
  v_mov_b32 v35, v179
  v_mov_b32 v36, v180
  v_mov_b32 v37, v181
  v_mov_b32 v38, v182
  v_mov_b32 v39, v183
  v_mov_b32 v40, v184
  v_mov_b32 v41, v185
  v_mov_b32 v42, v186
  v_mov_b32 v43, v187
  v_mov_b32 v44, v188
  v_mov_b32 v45, v189
  v_mov_b32 v46, v190
  v_mov_b32 v47, v191
  v_mov_b32 v48, v192
  v_mov_b32 v49, v193
  v_mov_b32 v50, v194
  v_mov_b32 v51, v195
  v_mov_b32 v52, v196
  v_mov_b32 v53, v197
  v_mov_b32 v54, v198
  v_mov_b32 v55, v199
  v_mov_b32 v56, v200
  v_mov_b32 v57, v201
  v_mov_b32 v58, v202
  v_mov_b32 v59, v203
  v_mov_b32 v60, v204
  v_mov_b32 v61, v205
  v_mov_b32 v62, v206
  v_mov_b32 v63, v207
  v_mov_b32 v64, v208
  v_mov_b32 v65, v209
  v_mov_b32 v66, v210
  v_mov_b32 v67, v211
  v_mov_b32 v68, v212
  v_mov_b32 v69, v213
  v_mov_b32 v70, v214
  v_mov_b32 v71, v215
  v_mov_b32 v72, v216
  v_mov_b32 v73, v217
  v_mov_b32 v74, v218
  v_mov_b32 v75, v219
  v_mov_b32 v76, v220
  v_mov_b32 v77, v221
  v_mov_b32 v78, v222
  v_mov_b32 v79, v223
  s_add_u32 s7, s7, 3
  s_add_u32 s8, s8, 49152
  s_cmp_ge_u32 s8, 147456
  s_cselect_b32 s57, 147456, 0
  s_sub_u32 s8, s8, s57
  s_waitcnt lgkmcnt(0)
  v_readfirstlane_b32 s56, v7
  s_lshl_b32 s57, s7, 1
  s_add_u32 s57, s57, 8
  s_cmp_lt_u32 s56, s57
  s_cbranch_scc1 L_noK
  s_cmp_ge_u32 s7, 30
  s_cbranch_scc1 L_noK
  s_add_u32 s57, s8, 49152
  s_cmp_ge_u32 s57, 147456
  s_cselect_b32 s58, 147456, 0
  s_sub_u32 s57, s57, s58
  v_add_u32 v12, s57, v9
  s_add_u32 s7, s7, 3
  ds_read_b128 v[160:163], v12 offset:0
  ds_read_b128 v[164:167], v12 offset:1024
  ds_read_b128 v[168:171], v12 offset:2048
  ds_read_b128 v[172:175], v12 offset:3072
  ds_read_b128 v[176:179], v12 offset:4096
  ds_read_b128 v[180:183], v12 offset:5120
  ds_read_b128 v[184:187], v12 offset:6144
  ds_read_b128 v[188:191], v12 offset:7168
  ds_read_b128 v[192:195], v12 offset:8192
  ds_read_b128 v[196:199], v12 offset:9216
  ds_read_b128 v[200:203], v12 offset:10240
  ds_read_b128 v[204:207], v12 offset:11264
  s_waitcnt lgkmcnt(8)
  ds_read_b128 v[208:211], v12 offset:12288
  ds_read_b128 v[212:215], v12 offset:13312
  ds_read_b128 v[216:219], v12 offset:14336
  ds_read_b128 v[220:223], v12 offset:15360
  s_add_u32 s57, s7, 1
  v_mov_b32 v7, s57
  s_waitcnt lgkmcnt(0)
  ds_write_b32 v15, v7
  s_sub_u32 s7, s7, 3
  s_mov_b32 s59, 2
  s_branch L_noK
L_fact:
  s_xor_b32 s57, s0, 32
po_25:
  buffer_load_dwordx4 v[136:139], v225, s[48:51], s0 offen sc1
  buffer_load_dwordx2 v[140:141], v225, s[48:51], s0 offen offset:16 sc1
  buffer_load_dwordx4 v[144:147], v225, s[48:51], s57 offen sc1
  buffer_load_dwordx2 v[148:149], v225, s[48:51], s57 offen offset:16 sc1
  s_waitcnt vmcnt(3)
  v_max3_u32 v7, v136, v137, v138
  v_max_u32 v7, v7, v139
  s_waitcnt vmcnt(2)
  v_max3_u32 v7, v7, v140, v141
  s_waitcnt vmcnt(1)
  v_max3_u32 v7, v7, v144, v145
  v_max3_u32 v7, v7, v146, v147
  s_waitcnt vmcnt(0)
  v_max3_u32 v7, v7, v148, v149
  v_cmp_eq_u32 vcc, -1, v7
  s_cbranch_vccz poe_26
  s_sleep 8
  s_sub_u32 s15, s15, 1
  s_cbranch_scc0 po_25
  s_mov_b32 s15, 0
poe_26:
  v_max3_f32 v4, v136, v138, v140
  v_max3_f32 v7, v144, v146, v148
  v_max_f32 v4, v4, v7
  v_sub_f32 v136, v136, v4
  v_sub_f32 v138, v138, v4
  v_sub_f32 v140, v140, v4
  v_sub_f32 v144, v144, v4
  v_sub_f32 v146, v146, v4
  v_sub_f32 v148, v148, v4
  v_mul_f32 v136, 0x3fb8aa3b, v136
  v_mul_f32 v138, 0x3fb8aa3b, v138
  v_mul_f32 v140, 0x3fb8aa3b, v140
  v_mul_f32 v144, 0x3fb8aa3b, v144
  v_mul_f32 v146, 0x3fb8aa3b, v146
  v_mul_f32 v148, 0x3fb8aa3b, v148
  v_exp_f32 v136, v136
  v_exp_f32 v138, v138
  v_exp_f32 v140, v140
  v_exp_f32 v144, v144
  v_exp_f32 v146, v146
  v_exp_f32 v148, v148
  s_nop 0
  v_mul_f32 v4, v136, v137
  v_mul_f32 v7, v144, v145
  v_fmac_f32 v4, v138, v139
  v_fmac_f32 v7, v146, v147
  v_fmac_f32 v4, v140, v141
  v_fmac_f32 v7, v148, v149
  v_add_f32 v4, v4, v7
  v_rcp_f32 v4, v4
  v_mov_b32 v8, 147496
  v_mul_f32 v96, v136, v4
  v_mul_f32 v98, v138, v4
  v_mul_f32 v100, v140, v4
  s_mov_b32 s58, 83333333
sp_27:
  ds_read_b32 v7, v8
  s_waitcnt lgkmcnt(0)
  v_readfirstlane_b32 s1, v7
  s_cmp_lg_u32 s1, 0
  s_cbranch_scc1 sp_27_ok
  s_sleep 1
  s_sub_u32 s58, s58, 1
  s_cbranch_scc0 sp_27
sp_27_ok:
  s_branch L_fact_r
L_aux:
  s_sub_u32 s9, s3, 4
  s_lshr_b32 s62, s9, 1
  s_and_b32 s63, s9, 1
  s_mov_b32 s60, 0x05040100
  s_mov_b32 s61, 0x07060302
  v_lshrrev_b32 v1, 4, v0
  v_and_b32 v2, 15, v0
  v_mov_b32 v3, 0
  v_lshlrev_b32 v4, 2, v0
  v_add_u32 v4, 147456, v4
  s_cmp_lg_u32 s9, 0
  s_cbranch_scc1 L_aux1
  ds_write_b32 v4, v3
L_aux1:
  s_mul_i32 s8, s9, 2176
  s_add_u32 s8, s8, 147712
  v_mul_u32_u24 v13, 272, v2
  v_lshl_add_u32 v13, v1, 6, v13
  v_add_u32 v13, s8, v13
  v_lshrrev_b32 v5, 5, v0
  v_lshl_add_u32 v13, v5, 4, v13
  v_bfe_u32 v5, v0, 2, 3
  v_mul_u32_u24 v14, 272, v5
  v_and_b32 v5, 1, v0
  v_lshl_add_u32 v14, v5, 5, v14
  v_lshlrev_b32 v15, 5, v5
  v_bfe_u32 v5, v0, 1, 1
  v_lshl_add_u32 v14, v5, 2, v14
  v_lshrrev_b32 v5, 5, v0
  v_lshl_add_u32 v14, v5, 3, v14
  s_lshl_b32 s8, s9, 6
  s_lshl4_add_u32 s8, s62, s8
  s_add_u32 s8, s8, 147712
  v_add_u32 v14, s8, v14
  v_mul_u32_u24 v5, 272, v5
  v_add_u32 v15, v15, v5
  v_bfe_u32 v5, v0, 1, 2
  v_lshl_add_u32 v15, v5, 2, v15
  v_bfe_u32 v5, v0, 3, 2
  v_lshl_add_u32 v15, v5, 6, v15
  v_and_b32 v5, 16, v0
  v_add_u32 v15, v5, v15
  s_mul_i32 s8, s9, 544
  s_add_u32 s8, s8, 147712
  v_add_u32 v15, s8, v15
  s_waitcnt lgkmcnt(0)
  s_mov_b32 s48, s42
  s_mov_b32 s49, s43
  s_mov_b32 s50, 1064960
  s_mov_b32 s51, 0x20000
  s_mov_b32 s52, s40
  s_mov_b32 s53, s41
  s_mov_b32 s54, 256
  s_mov_b32 s55, 0x20000
  s_cmp_lt_u32 s5, 9
  s_cbranch_scc1 L_nop
  s_cmp_lt_u32 s2, 81
  s_cbranch_scc1 L_pH
  s_cmp_lt_u32 s5, 13
  s_cbranch_scc1 L_nop
  s_cmp_lt_u32 s5, 21
  s_cbranch_scc1 L_p2
  s_cmp_lt_u32 s5, 27
  s_cbranch_scc1 L_nop
  s_cmp_lt_u32 s5, 30
  s_cbranch_scc1 L_clrB
  s_cmp_lt_u32 s2, 252
  s_cbranch_scc1 L_nop
  s_barrier
  s_cmp_lg_u32 s9, 0
  s_cbranch_scc1 L_clr_done
  s_sub_u32 s7, s2, 252
  s_lshl_b32 s7, s7, 2
  v_mov_b32 v10, 0
  v_mov_b32 v11, 1
  s_mov_b64 exec, 1
  buffer_store_dword v11, v10, s[52:55], s7 offen sc1
  s_branch L_clr_done
L_clrB:
  v_mov_b32 v8, -1
  v_mov_b32 v9, -1
  v_mov_b32 v10, -1
  v_mov_b32 v11, -1
  v_lshlrev_b32 v3, 4, v0
  s_sub_u32 s7, s2, 216
  s_lshl_b32 s6, s7, 2
  s_add_u32 s6, s6, s9
  s_mul_i32 s6, s6, 7168
  s_add_u32 s6, s6, 86016
  buffer_store_dwordx4 v[8:11], v3, s[48:51], s6 offen offset:0 sc1
  buffer_store_dwordx4 v[8:11], v3, s[48:51], s6 offen offset:1024 sc1
  buffer_store_dwordx4 v[8:11], v3, s[48:51], s6 offen offset:2048 sc1
  buffer_store_dwordx4 v[8:11], v3, s[48:51], s6 offen offset:3072 sc1
  s_add_u32 s6, s6, 4096
  buffer_store_dwordx4 v[8:11], v3, s[48:51], s6 offen offset:0 sc1
  buffer_store_dwordx4 v[8:11], v3, s[48:51], s6 offen offset:1024 sc1
  buffer_store_dwordx4 v[8:11], v3, s[48:51], s6 offen offset:2048 sc1
  s_barrier
  s_waitcnt vmcnt(0)
  v_mov_b32 v10, 147488
  v_mov_b32 v11, 1
  s_mov_b64 exec, 1
  ds_add_rtn_u32 v12, v10, v11
  s_waitcnt lgkmcnt(0)
  v_readfirstlane_b32 s8, v12
  s_cmp_lg_u32 s8, 3
  s_cbranch_scc1 L_clr_done
  v_mov_b32 v10, 0
  v_mov_b32 v12, 1
  buffer_atomic_add v12, v10, s[52:55], 0 offen offset:128 sc0 sc1
  s_waitcnt vmcnt(0)
  v_readfirstlane_b32 s8, v12
  s_cmp_lg_u32 s8, 23
  s_cbranch_scc1 L_clr_done
  buffer_store_dword v11, v10, s[52:55], 0 offen offset:16 sc1
L_clr_done:
  s_mov_b64 exec, -1
  v_mov_b32 v10, 147492
  v_mov_b32 v11, 1
  s_mov_b64 exec, 1
  ds_add_u32 v10, v11
  s_mov_b64 exec, -1
  s_branch L_mid
L_nop:
  s_barrier
  s_branch L_mid
L_pH:
  s_sub_u32 s56, s2, 72
  s_mul_i32 s8, s9, 5
  s_min_u32 s8, s8, 14
  s_mul_i32 s6, s8, 221184
  s_lshl_b32 s7, s56, 7
  s_add_u32 s6, s6, s7
  s_lshl_b32 s8, s8, 6
  v_and_b32 v5, 7, v0
  v_bfe_u32 v7, v0, 3, 1
  v_mul_u32_u24 v6, 1152, v5
  v_lshl_add_u32 v6, v1, 4, v6
  v_lshl_add_u32 v6, v7, 6, v6
  v_mul_u32_u24 v3, 55296, v1
  v_lshl_add_u32 v3, v5, 4, v3
  v_mul_u32_u24 v7, 1152, v7
  v_add_u32 v3, v3, v7
  s_mov_b32 s44, s34
  s_mov_b32 s45, s35
  s_mov_b32 s46, 9216
  s_mov_b32 s47, 0x20000
  buffer_load_dwordx4 v[208:211], v6, s[44:47], s8 offen offset:0
  buffer_load_dwordx4 v[216:219], v6, s[44:47], s8 offen offset:128
  buffer_load_dwordx4 v[224:227], v6, s[44:47], s8 offen offset:256
  s_mov_b32 s44, s16
  s_mov_b32 s45, s17
  s_mov_b32 s46, 9216
  s_mov_b32 s47, 0x20000
  v_lshrrev_b32 v5, 5, v0
  v_lshlrev_b32 v7, 4, v5
  v_mul_u32_u24 v5, 1152, v5
  v_and_b32 v6, 31, v0
  v_lshl_add_u32 v5, v6, 2, v5
  v_and_b32 v6, 3, v0
  v_lshl_add_u32 v7, v6, 2, v7
  v_bfe_u32 v6, v0, 2, 3
  v_mul_u32_u24 v6, 1152, v6
  v_add_u32 v7, v7, v6
  s_mul_i32 s8, s9, 2304
  buffer_load_dword v228, v5, s[44:47], s8 offen offset:0
  buffer_load_dword v229, v5, s[44:47], s8 offen offset:128
  buffer_load_dword v230, v5, s[44:47], s8 offen offset:256
  buffer_load_dword v231, v5, s[44:47], s8 offen offset:384
  buffer_load_dword v232, v5, s[44:47], s8 offen offset:512
  buffer_load_dword v233, v5, s[44:47], s8 offen offset:640
  buffer_load_dword v234, v5, s[44:47], s8 offen offset:768
  buffer_load_dword v235, v5, s[44:47], s8 offen offset:896
  buffer_load_dword v236, v5, s[44:47], s8 offen offset:1024
  s_lshl_b32 s59, s56, 7
  s_lshl_b32 s8, s9, 5
  s_add_u32 s59, s59, s8
  buffer_load_dword v237, v7, s[44:47], s59 offen
  s_mov_b32 s44, s36
  s_mov_b32 s45, s37
  s_mov_b32 s46, 3981312
  s_mov_b32 s47, 0x20000
  buffer_load_dwordx4 v[16:19], v3, s[44:47], s6 offen
  s_add_u32 s6, s6, 6912
  buffer_load_dwordx4 v[20:23], v3, s[44:47], s6 offen
  s_add_u32 s6, s6, 6912
  buffer_load_dwordx4 v[24:27], v3, s[44:47], s6 offen
  s_add_u32 s6, s6, 6912
  buffer_load_dwordx4 v[28:31], v3, s[44:47], s6 offen
  s_add_u32 s6, s6, 6912
  buffer_load_dwordx4 v[32:35], v3, s[44:47], s6 offen
  s_add_u32 s6, s6, 6912
  buffer_load_dwordx4 v[36:39], v3, s[44:47], s6 offen
  s_barrier
  s_waitcnt vmcnt(16)
  s_waitcnt vmcnt(6)
  s_add_u32 s6, s6, 6912
  buffer_load_dwordx4 v[40:43], v3, s[44:47], s6 offen
  v_lshlrev_b32 v240, 16, v208
  v_and_b32 v241, 0xffff0000, v208
  v_lshlrev_b32 v242, 16, v209
  v_and_b32 v243, 0xffff0000, v209
  v_lshlrev_b32 v244, 16, v210
  v_and_b32 v245, 0xffff0000, v210
  v_lshlrev_b32 v246, 16, v211
  v_and_b32 v247, 0xffff0000, v211
  v_max_f32 v240, 0xc2ae0000, v240
  v_max_f32 v241, 0xc2ae0000, v241
  v_max_f32 v242, 0xc2ae0000, v242
  s_add_u32 s6, s6, 6912
  buffer_load_dwordx4 v[44:47], v3, s[44:47], s6 offen
  v_max_f32 v243, 0xc2ae0000, v243
  v_max_f32 v244, 0xc2ae0000, v244
  v_max_f32 v245, 0xc2ae0000, v245
  v_max_f32 v246, 0xc2ae0000, v246
  v_max_f32 v247, 0xc2ae0000, v247
  v_mul_f32 v248, 0xbfb8aa3b, v240
  v_mul_f32 v249, 0xbfb8aa3b, v241
  v_mul_f32 v250, 0xbfb8aa3b, v242
  v_mul_f32 v251, 0xbfb8aa3b, v243
  v_mul_f32 v252, 0xbfb8aa3b, v244
  v_mul_f32 v253, 0xbfb8aa3b, v245
  s_add_u32 s6, s6, 172800
  buffer_load_dwordx4 v[48:51], v3, s[44:47], s6 offen
  v_mul_f32 v254, 0xbfb8aa3b, v246
  v_mul_f32 v255, 0xbfb8aa3b, v247
  v_exp_f32 v248, v248
  v_exp_f32 v249, v249
  v_exp_f32 v250, v250
  v_exp_f32 v251, v251
  v_exp_f32 v252, v252
  v_exp_f32 v253, v253
  v_exp_f32 v254, v254
  v_exp_f32 v255, v255
  v_add_f32 v248, 1.0, v248
  s_add_u32 s6, s6, 6912
  buffer_load_dwordx4 v[52:55], v3, s[44:47], s6 offen
  v_add_f32 v249, 1.0, v249
  v_add_f32 v250, 1.0, v250
  v_add_f32 v251, 1.0, v251
  v_add_f32 v252, 1.0, v252
  v_add_f32 v253, 1.0, v253
  v_add_f32 v254, 1.0, v254
  v_add_f32 v255, 1.0, v255
  v_rcp_f32 v176, v248
  v_rcp_f32 v177, v249
  v_rcp_f32 v178, v250
  v_rcp_f32 v179, v251
  s_add_u32 s6, s6, 6912
  buffer_load_dwordx4 v[56:59], v3, s[44:47], s6 offen
  v_rcp_f32 v180, v252
  v_rcp_f32 v181, v253
  v_rcp_f32 v182, v254
  v_rcp_f32 v183, v255
  v_mul_f32 v184, v240, v176
  v_mul_f32 v185, v241, v177
  v_mul_f32 v186, v242, v178
  v_mul_f32 v187, v243, v179
  v_mul_f32 v188, v244, v180
  v_mul_f32 v189, v245, v181
  v_mul_f32 v190, v246, v182
  s_add_u32 s6, s6, 6912
  buffer_load_dwordx4 v[60:63], v3, s[44:47], s6 offen
  v_mul_f32 v191, v247, v183
  v_fma_f32 v248, -v184, v248, v240
  v_fma_f32 v249, -v185, v249, v241
  v_fma_f32 v250, -v186, v250, v242
  v_fma_f32 v251, -v187, v251, v243
  v_fma_f32 v252, -v188, v252, v244
  v_fma_f32 v253, -v189, v253, v245
  v_fma_f32 v254, -v190, v254, v246
  v_fma_f32 v255, -v191, v255, v247
  v_fma_f32 v240, v248, v176, v184
  v_fma_f32 v241, v249, v177, v185
  s_add_u32 s6, s6, 6912
  buffer_load_dwordx4 v[64:67], v3, s[44:47], s6 offen
  v_fma_f32 v242, v250, v178, v186
  v_fma_f32 v243, v251, v179, v187
  v_fma_f32 v244, v252, v180, v188
  v_fma_f32 v245, v253, v181, v189
  v_fma_f32 v246, v254, v182, v190
  v_fma_f32 v247, v255, v183, v191
  v_cvt_pk_bf16_f32 v208, v240, v241
  v_cvt_pk_bf16_f32 v209, v242, v243
  v_cvt_pk_bf16_f32 v210, v244, v245
  v_cvt_pk_bf16_f32 v211, v246, v247
  s_nop 0
  s_add_u32 s6, s6, 6912
  buffer_load_dwordx4 v[68:71], v3, s[44:47], s6 offen
  v_mov_b32 v212, v208 row_ror:8 row_mask:0xf bank_mask:0xf
  v_mov_b32 v213, v209 row_ror:8 row_mask:0xf bank_mask:0xf
  v_mov_b32 v214, v210 row_ror:8 row_mask:0xf bank_mask:0xf
  v_mov_b32 v215, v211 row_ror:8 row_mask:0xf bank_mask:0xf
  v_lshlrev_b32 v240, 16, v216
  v_and_b32 v241, 0xffff0000, v216
  v_lshlrev_b32 v242, 16, v217
  v_and_b32 v243, 0xffff0000, v217
  v_lshlrev_b32 v244, 16, v218
  v_and_b32 v245, 0xffff0000, v218
  v_lshlrev_b32 v246, 16, v219
  s_add_u32 s6, s6, 6912
  buffer_load_dwordx4 v[72:75], v3, s[44:47], s6 offen
  v_and_b32 v247, 0xffff0000, v219
  v_max_f32 v240, 0xc2ae0000, v240
  v_max_f32 v241, 0xc2ae0000, v241
  v_max_f32 v242, 0xc2ae0000, v242
  v_max_f32 v243, 0xc2ae0000, v243
  v_max_f32 v244, 0xc2ae0000, v244
  v_max_f32 v245, 0xc2ae0000, v245
  v_max_f32 v246, 0xc2ae0000, v246
  v_max_f32 v247, 0xc2ae0000, v247
  v_mul_f32 v248, 0xbfb8aa3b, v240
  v_mul_f32 v249, 0xbfb8aa3b, v241
  s_add_u32 s6, s6, 6912
  buffer_load_dwordx4 v[76:79], v3, s[44:47], s6 offen
  v_mul_f32 v250, 0xbfb8aa3b, v242
  v_mul_f32 v251, 0xbfb8aa3b, v243
  v_mul_f32 v252, 0xbfb8aa3b, v244
  v_mul_f32 v253, 0xbfb8aa3b, v245
  v_mul_f32 v254, 0xbfb8aa3b, v246
  v_mul_f32 v255, 0xbfb8aa3b, v247
  v_exp_f32 v248, v248
  v_exp_f32 v249, v249
  v_exp_f32 v250, v250
  v_exp_f32 v251, v251
  v_exp_f32 v252, v252
  s_add_u32 s6, s6, 172800
  buffer_load_dwordx4 v[80:83], v3, s[44:47], s6 offen
  v_exp_f32 v253, v253
  v_exp_f32 v254, v254
  v_exp_f32 v255, v255
  v_add_f32 v248, 1.0, v248
  v_add_f32 v249, 1.0, v249
  v_add_f32 v250, 1.0, v250
  v_add_f32 v251, 1.0, v251
  v_add_f32 v252, 1.0, v252
  v_add_f32 v253, 1.0, v253
  v_add_f32 v254, 1.0, v254
  v_add_f32 v255, 1.0, v255
  s_add_u32 s6, s6, 6912
  buffer_load_dwordx4 v[84:87], v3, s[44:47], s6 offen
  v_rcp_f32 v176, v248
  v_rcp_f32 v177, v249
  v_rcp_f32 v178, v250
  v_rcp_f32 v179, v251
  v_rcp_f32 v180, v252
  v_rcp_f32 v181, v253
  v_rcp_f32 v182, v254
  v_rcp_f32 v183, v255
  v_mul_f32 v184, v240, v176
  v_mul_f32 v185, v241, v177
  v_mul_f32 v186, v242, v178
  s_add_u32 s6, s6, 6912
  buffer_load_dwordx4 v[88:91], v3, s[44:47], s6 offen
  v_mul_f32 v187, v243, v179
  v_mul_f32 v188, v244, v180
  v_mul_f32 v189, v245, v181
  v_mul_f32 v190, v246, v182
  v_mul_f32 v191, v247, v183
  v_fma_f32 v248, -v184, v248, v240
  v_fma_f32 v249, -v185, v249, v241
  v_fma_f32 v250, -v186, v250, v242
  v_fma_f32 v251, -v187, v251, v243
  v_fma_f32 v252, -v188, v252, v244
  v_fma_f32 v253, -v189, v253, v245
  s_add_u32 s6, s6, 6912
  buffer_load_dwordx4 v[92:95], v3, s[44:47], s6 offen
  v_fma_f32 v254, -v190, v254, v246
  v_fma_f32 v255, -v191, v255, v247
  v_fma_f32 v240, v248, v176, v184
  v_fma_f32 v241, v249, v177, v185
  v_fma_f32 v242, v250, v178, v186
  v_fma_f32 v243, v251, v179, v187
  v_fma_f32 v244, v252, v180, v188
  v_fma_f32 v245, v253, v181, v189
  v_fma_f32 v246, v254, v182, v190
  v_fma_f32 v247, v255, v183, v191
  v_cvt_pk_bf16_f32 v216, v240, v241
  s_add_u32 s6, s6, 6912
  buffer_load_dwordx4 v[96:99], v3, s[44:47], s6 offen
  v_cvt_pk_bf16_f32 v217, v242, v243
  v_cvt_pk_bf16_f32 v218, v244, v245
  v_cvt_pk_bf16_f32 v219, v246, v247
  s_nop 0
  v_mov_b32 v220, v216 row_ror:8 row_mask:0xf bank_mask:0xf
  v_mov_b32 v221, v217 row_ror:8 row_mask:0xf bank_mask:0xf
  v_mov_b32 v222, v218 row_ror:8 row_mask:0xf bank_mask:0xf
  v_mov_b32 v223, v219 row_ror:8 row_mask:0xf bank_mask:0xf
  v_lshlrev_b32 v240, 16, v224
  v_and_b32 v241, 0xffff0000, v224
  v_lshlrev_b32 v242, 16, v225
  s_add_u32 s6, s6, 6912
  buffer_load_dwordx4 v[100:103], v3, s[44:47], s6 offen
  v_and_b32 v243, 0xffff0000, v225
  v_lshlrev_b32 v244, 16, v226
  v_and_b32 v245, 0xffff0000, v226
  v_lshlrev_b32 v246, 16, v227
  v_and_b32 v247, 0xffff0000, v227
  v_max_f32 v240, 0xc2ae0000, v240
  v_max_f32 v241, 0xc2ae0000, v241
  v_max_f32 v242, 0xc2ae0000, v242
  v_max_f32 v243, 0xc2ae0000, v243
  v_max_f32 v244, 0xc2ae0000, v244
  v_max_f32 v245, 0xc2ae0000, v245
  s_add_u32 s6, s6, 6912
  buffer_load_dwordx4 v[104:107], v3, s[44:47], s6 offen
  v_max_f32 v246, 0xc2ae0000, v246
  v_max_f32 v247, 0xc2ae0000, v247
  v_mul_f32 v248, 0xbfb8aa3b, v240
  v_mul_f32 v249, 0xbfb8aa3b, v241
  v_mul_f32 v250, 0xbfb8aa3b, v242
  v_mul_f32 v251, 0xbfb8aa3b, v243
  v_mul_f32 v252, 0xbfb8aa3b, v244
  v_mul_f32 v253, 0xbfb8aa3b, v245
  v_mul_f32 v254, 0xbfb8aa3b, v246
  v_mul_f32 v255, 0xbfb8aa3b, v247
  v_exp_f32 v248, v248
  s_add_u32 s6, s6, 6912
  buffer_load_dwordx4 v[108:111], v3, s[44:47], s6 offen
  v_exp_f32 v249, v249
  v_exp_f32 v250, v250
  v_exp_f32 v251, v251
  v_exp_f32 v252, v252
  v_exp_f32 v253, v253
  v_exp_f32 v254, v254
  v_exp_f32 v255, v255
  v_add_f32 v248, 1.0, v248
  v_add_f32 v249, 1.0, v249
  v_add_f32 v250, 1.0, v250
  v_add_f32 v251, 1.0, v251
  s_add_u32 s6, s6, 172800
  buffer_load_dwordx4 v[112:115], v3, s[44:47], s6 offen
  v_add_f32 v252, 1.0, v252
  v_add_f32 v253, 1.0, v253
  v_add_f32 v254, 1.0, v254
  v_add_f32 v255, 1.0, v255
  v_rcp_f32 v176, v248
  v_rcp_f32 v177, v249
  v_rcp_f32 v178, v250
  v_rcp_f32 v179, v251
  v_rcp_f32 v180, v252
  v_rcp_f32 v181, v253
  v_rcp_f32 v182, v254
  s_add_u32 s6, s6, 6912
  buffer_load_dwordx4 v[116:119], v3, s[44:47], s6 offen
  v_rcp_f32 v183, v255
  v_mul_f32 v184, v240, v176
  v_mul_f32 v185, v241, v177
  v_mul_f32 v186, v242, v178
  v_mul_f32 v187, v243, v179
  v_mul_f32 v188, v244, v180
  v_mul_f32 v189, v245, v181
  v_mul_f32 v190, v246, v182
  v_mul_f32 v191, v247, v183
  v_fma_f32 v248, -v184, v248, v240
  v_fma_f32 v249, -v185, v249, v241
  s_add_u32 s6, s6, 6912
  buffer_load_dwordx4 v[120:123], v3, s[44:47], s6 offen
  v_fma_f32 v250, -v186, v250, v242
  v_fma_f32 v251, -v187, v251, v243
  v_fma_f32 v252, -v188, v252, v244
  v_fma_f32 v253, -v189, v253, v245
  v_fma_f32 v254, -v190, v254, v246
  v_fma_f32 v255, -v191, v255, v247
  v_fma_f32 v240, v248, v176, v184
  v_fma_f32 v241, v249, v177, v185
  v_fma_f32 v242, v250, v178, v186
  v_fma_f32 v243, v251, v179, v187
  v_fma_f32 v244, v252, v180, v188
  s_add_u32 s6, s6, 6912
  buffer_load_dwordx4 v[124:127], v3, s[44:47], s6 offen
  v_fma_f32 v245, v253, v181, v189
  v_fma_f32 v246, v254, v182, v190
  v_fma_f32 v247, v255, v183, v191
  v_cvt_pk_bf16_f32 v224, v240, v241
  v_cvt_pk_bf16_f32 v225, v242, v243
  v_cvt_pk_bf16_f32 v226, v244, v245
  v_cvt_pk_bf16_f32 v227, v246, v247
  v_lshlrev_b32 v176, 16, v228
  v_and_b32 v177, 0xffff0000, v228
  v_lshlrev_b32 v178, 16, v229
  v_and_b32 v179, 0xffff0000, v229
  s_add_u32 s6, s6, 6912
  buffer_load_dwordx4 v[128:131], v3, s[44:47], s6 offen
  v_lshlrev_b32 v180, 16, v230
  v_and_b32 v181, 0xffff0000, v230
  v_lshlrev_b32 v182, 16, v231
  v_and_b32 v183, 0xffff0000, v231
  v_lshlrev_b32 v184, 16, v232
  v_and_b32 v185, 0xffff0000, v232
  v_lshlrev_b32 v186, 16, v233
  v_and_b32 v187, 0xffff0000, v233
  v_lshlrev_b32 v188, 16, v234
  v_and_b32 v189, 0xffff0000, v234
  v_lshlrev_b32 v190, 16, v235
  s_add_u32 s6, s6, 6912
  buffer_load_dwordx4 v[132:135], v3, s[44:47], s6 offen
  v_and_b32 v191, 0xffff0000, v235
  v_lshlrev_b32 v192, 16, v236
  v_and_b32 v193, 0xffff0000, v236
  v_add_f32 v8, v176, v177
  v_add_f32 v8, v8, v178
  v_add_f32 v8, v8, v179
  v_add_f32 v8, v8, v180
  v_add_f32 v8, v8, v181
  v_add_f32 v8, v8, v182
  v_add_f32 v8, v8, v183
  v_add_f32 v8, v8, v184
  s_add_u32 s6, s6, 6912
  buffer_load_dwordx4 v[136:139], v3, s[44:47], s6 offen
  v_add_f32 v8, v8, v185
  v_add_f32 v8, v8, v186
  v_add_f32 v8, v8, v187
  v_add_f32 v8, v8, v188
  v_add_f32 v8, v8, v189
  v_add_f32 v8, v8, v190
  v_add_f32 v8, v8, v191
  v_add_f32 v8, v8, v192
  v_add_f32 v8, v8, v193
  s_nop 1
  v_add_f32 v8, v8, v8 row_ror:1 row_mask:0xf bank_mask:0xf
  s_add_u32 s6, s6, 6912
  buffer_load_dwordx4 v[140:143], v3, s[44:47], s6 offen
  s_nop 1
  v_add_f32 v8, v8, v8 row_ror:2 row_mask:0xf bank_mask:0xf
  s_nop 1
  v_add_f32 v8, v8, v8 row_ror:4 row_mask:0xf bank_mask:0xf
  s_nop 1
  v_add_f32 v8, v8, v8 row_ror:8 row_mask:0xf bank_mask:0xf
  v_mov_b32 v10, v8
  s_nop 1
  v_permlane16_swap_b32 v8, v10
  v_add_f32 v8, v8, v10
  v_mul_f32 v8, 0x3ae38e39, v8
  s_add_u32 s6, s6, 172800
  s_cmp_ge_u32 s9, 2
  s_cselect_b32 s46, 0, s46
  buffer_load_dwordx4 v[144:147], v3, s[44:47], s6 offen
  v_mov_b32 v9, 0
  v_sub_f32 v10, v176, v8
  v_fmac_f32 v9, v10, v10
  v_sub_f32 v10, v177, v8
  v_fmac_f32 v9, v10, v10
  v_sub_f32 v10, v178, v8
  v_fmac_f32 v9, v10, v10
  v_sub_f32 v10, v179, v8
  v_fmac_f32 v9, v10, v10
  v_sub_f32 v10, v180, v8
  v_fmac_f32 v9, v10, v10
  s_add_u32 s6, s6, 6912
  buffer_load_dwordx4 v[148:151], v3, s[44:47], s6 offen
  v_sub_f32 v10, v181, v8
  v_fmac_f32 v9, v10, v10
  v_sub_f32 v10, v182, v8
  v_fmac_f32 v9, v10, v10
  v_sub_f32 v10, v183, v8
  v_fmac_f32 v9, v10, v10
  v_sub_f32 v10, v184, v8
  v_fmac_f32 v9, v10, v10
  v_sub_f32 v10, v185, v8
  v_fmac_f32 v9, v10, v10
  v_sub_f32 v10, v186, v8
  s_add_u32 s6, s6, 6912
  buffer_load_dwordx4 v[152:155], v3, s[44:47], s6 offen
  v_fmac_f32 v9, v10, v10
  v_sub_f32 v10, v187, v8
  v_fmac_f32 v9, v10, v10
  v_sub_f32 v10, v188, v8
  v_fmac_f32 v9, v10, v10
  v_sub_f32 v10, v189, v8
  v_fmac_f32 v9, v10, v10
  v_sub_f32 v10, v190, v8
  v_fmac_f32 v9, v10, v10
  v_sub_f32 v10, v191, v8
  v_fmac_f32 v9, v10, v10
  s_add_u32 s6, s6, 6912
  buffer_load_dwordx4 v[156:159], v3, s[44:47], s6 offen
  v_sub_f32 v10, v192, v8
  v_fmac_f32 v9, v10, v10
  v_sub_f32 v10, v193, v8
  v_fmac_f32 v9, v10, v10
  s_nop 1
  v_add_f32 v9, v9, v9 row_ror:1 row_mask:0xf bank_mask:0xf
  s_nop 1
  v_add_f32 v9, v9, v9 row_ror:2 row_mask:0xf bank_mask:0xf
  s_nop 1
  v_add_f32 v9, v9, v9 row_ror:4 row_mask:0xf bank_mask:0xf
  s_nop 1
  s_add_u32 s6, s6, 6912
  buffer_load_dwordx4 v[160:163], v3, s[44:47], s6 offen
  v_add_f32 v9, v9, v9 row_ror:8 row_mask:0xf bank_mask:0xf
  v_mov_b32 v10, v9
  s_nop 1
  v_permlane16_swap_b32 v9, v10
  v_add_f32 v9, v9, v10
  v_mul_f32 v9, 0x3ae38e39, v9
  v_cvt_pk_bf16_f32 v8, v8, v8
  v_lshlrev_b32 v8, 16, v8
  v_cvt_pk_bf16_f32 v9, v9, v9
  v_lshlrev_b32 v9, 16, v9
  v_add_f32 v9, 0x3727c5ac, v9
  s_add_u32 s6, s6, 6912
  buffer_load_dwordx4 v[164:167], v3, s[44:47], s6 offen
  v_cvt_pk_bf16_f32 v9, v9, v9
  v_lshlrev_b32 v9, 16, v9
  v_sqrt_f32 v9, v9
  s_nop 0
  v_cvt_pk_bf16_f32 v9, v9, v9
  v_lshlrev_b32 v9, 16, v9
  v_rcp_f32 v9, v9
  s_nop 0
  s_add_u32 s6, s6, 6912
  buffer_load_dwordx4 v[168:171], v3, s[44:47], s6 offen
  s_add_u32 s6, s6, 6912
  buffer_load_dwordx4 v[172:175], v3, s[44:47], s6 offen
  v_and_b32 v5, 7, v0
  v_lshlrev_b32 v5, 2, v5
  buffer_load_dword v6, v5, s[52:55], 0 offen sc1
  v_lshrrev_b32 v12, 5, v0
  s_lshl_b32 s8, s9, 4
  s_add_u32 s8, s8, 147520
  v_lshl_add_u32 v12, v12, 3, s8
  s_mov_b32 s10, 1
  s_mov_b32 s11, 1
  s_mov_b64 exec, s[10:11]
  ds_write_b64 v12, v[8:9]
  s_mov_b64 exec, -1
  v_mov_b32 v10, 147492
  v_mov_b32 v11, 1
  s_mov_b64 exec, 1
  ds_add_u32 v10, v11
  s_mov_b64 exec, -1
  s_waitcnt vmcnt(33)
  v_perm_b32 v240, v20, v16, s60
  v_perm_b32 v241, v28, v24, s60
  v_perm_b32 v242, v36, v32, s60
  v_perm_b32 v243, v44, v40, s60
  v_perm_b32 v244, v20, v16, s61
  v_perm_b32 v245, v28, v24, s61
  v_perm_b32 v246, v36, v32, s61
  v_perm_b32 v247, v44, v40, s61
  v_mfma_f32_16x16x32_bf16 v[176:179], v[240:243], v[208:211], 0
  v_perm_b32 v248, v21, v17, s60
  v_perm_b32 v249, v29, v25, s60
  v_perm_b32 v250, v37, v33, s60
  v_perm_b32 v251, v45, v41, s60
  v_mfma_f32_16x16x32_bf16 v[180:183], v[244:247], v[208:211], 0
  v_perm_b32 v252, v21, v17, s61
  v_perm_b32 v253, v29, v25, s61
  v_perm_b32 v254, v37, v33, s61
  v_perm_b32 v255, v45, v41, s61
  v_mfma_f32_16x16x32_bf16 v[184:187], v[248:251], v[208:211], 0
  v_perm_b32 v240, v22, v18, s60
  v_perm_b32 v241, v30, v26, s60
  v_perm_b32 v242, v38, v34, s60
  v_perm_b32 v243, v46, v42, s60
  v_mfma_f32_16x16x32_bf16 v[188:191], v[252:255], v[208:211], 0
  v_perm_b32 v244, v22, v18, s61
  v_perm_b32 v245, v30, v26, s61
  v_perm_b32 v246, v38, v34, s61
  v_perm_b32 v247, v46, v42, s61
  v_mfma_f32_16x16x32_bf16 v[192:195], v[240:243], v[208:211], 0
  v_perm_b32 v248, v23, v19, s60
  v_perm_b32 v249, v31, v27, s60
  v_perm_b32 v250, v39, v35, s60
  v_perm_b32 v251, v47, v43, s60
  v_mfma_f32_16x16x32_bf16 v[196:199], v[244:247], v[208:211], 0
  v_perm_b32 v252, v23, v19, s61
  v_perm_b32 v253, v31, v27, s61
  v_perm_b32 v254, v39, v35, s61
  v_perm_b32 v255, v47, v43, s61
  v_mfma_f32_16x16x32_bf16 v[200:203], v[248:251], v[208:211], 0
  s_nop 1
  v_mfma_f32_16x16x32_bf16 v[204:207], v[252:255], v[208:211], 0
  s_waitcnt vmcnt(25)
  v_perm_b32 v240, v52, v48, s60
  v_perm_b32 v241, v60, v56, s60
  v_perm_b32 v242, v68, v64, s60
  v_perm_b32 v243, v76, v72, s60
  v_perm_b32 v244, v52, v48, s61
  v_perm_b32 v245, v60, v56, s61
  v_perm_b32 v246, v68, v64, s61
  v_perm_b32 v247, v76, v72, s61
  v_mfma_f32_16x16x32_bf16 v[176:179], v[240:243], v[212:215], v[176:179]
  v_perm_b32 v248, v53, v49, s60
  v_perm_b32 v249, v61, v57, s60
  v_perm_b32 v250, v69, v65, s60
  v_perm_b32 v251, v77, v73, s60
  v_mfma_f32_16x16x32_bf16 v[180:183], v[244:247], v[212:215], v[180:183]
  v_perm_b32 v252, v53, v49, s61
  v_perm_b32 v253, v61, v57, s61
  v_perm_b32 v254, v69, v65, s61
  v_perm_b32 v255, v77, v73, s61
  v_mfma_f32_16x16x32_bf16 v[184:187], v[248:251], v[212:215], v[184:187]
  v_perm_b32 v240, v54, v50, s60
  v_perm_b32 v241, v62, v58, s60
  v_perm_b32 v242, v70, v66, s60
  v_perm_b32 v243, v78, v74, s60
  v_mfma_f32_16x16x32_bf16 v[188:191], v[252:255], v[212:215], v[188:191]
  v_perm_b32 v244, v54, v50, s61
  v_perm_b32 v245, v62, v58, s61
  v_perm_b32 v246, v70, v66, s61
  v_perm_b32 v247, v78, v74, s61
  v_mfma_f32_16x16x32_bf16 v[192:195], v[240:243], v[212:215], v[192:195]
  v_perm_b32 v248, v55, v51, s60
  v_perm_b32 v249, v63, v59, s60
  v_perm_b32 v250, v71, v67, s60
  v_perm_b32 v251, v79, v75, s60
  v_mfma_f32_16x16x32_bf16 v[196:199], v[244:247], v[212:215], v[196:199]
  v_perm_b32 v252, v55, v51, s61
  v_perm_b32 v253, v63, v59, s61
  v_perm_b32 v254, v71, v67, s61
  v_perm_b32 v255, v79, v75, s61
  v_mfma_f32_16x16x32_bf16 v[200:203], v[248:251], v[212:215], v[200:203]
  s_nop 1
  v_mfma_f32_16x16x32_bf16 v[204:207], v[252:255], v[212:215], v[204:207]
  s_waitcnt vmcnt(17)
  v_perm_b32 v240, v84, v80, s60
  v_perm_b32 v241, v92, v88, s60
  v_perm_b32 v242, v100, v96, s60
  v_perm_b32 v243, v108, v104, s60
  v_perm_b32 v244, v84, v80, s61
  v_perm_b32 v245, v92, v88, s61
  v_perm_b32 v246, v100, v96, s61
  v_perm_b32 v247, v108, v104, s61
  v_mfma_f32_16x16x32_bf16 v[176:179], v[240:243], v[216:219], v[176:179]
  v_perm_b32 v248, v85, v81, s60
  v_perm_b32 v249, v93, v89, s60
  v_perm_b32 v250, v101, v97, s60
  v_perm_b32 v251, v109, v105, s60
  v_mfma_f32_16x16x32_bf16 v[180:183], v[244:247], v[216:219], v[180:183]
  v_perm_b32 v252, v85, v81, s61
  v_perm_b32 v253, v93, v89, s61
  v_perm_b32 v254, v101, v97, s61
  v_perm_b32 v255, v109, v105, s61
  v_mfma_f32_16x16x32_bf16 v[184:187], v[248:251], v[216:219], v[184:187]
  v_perm_b32 v240, v86, v82, s60
  v_perm_b32 v241, v94, v90, s60
  v_perm_b32 v242, v102, v98, s60
  v_perm_b32 v243, v110, v106, s60
  v_mfma_f32_16x16x32_bf16 v[188:191], v[252:255], v[216:219], v[188:191]
  v_perm_b32 v244, v86, v82, s61
  v_perm_b32 v245, v94, v90, s61
  v_perm_b32 v246, v102, v98, s61
  v_perm_b32 v247, v110, v106, s61
  v_mfma_f32_16x16x32_bf16 v[192:195], v[240:243], v[216:219], v[192:195]
  v_perm_b32 v248, v87, v83, s60
  v_perm_b32 v249, v95, v91, s60
  v_perm_b32 v250, v103, v99, s60
  v_perm_b32 v251, v111, v107, s60
  v_mfma_f32_16x16x32_bf16 v[196:199], v[244:247], v[216:219], v[196:199]
  v_perm_b32 v252, v87, v83, s61
  v_perm_b32 v253, v95, v91, s61
  v_perm_b32 v254, v103, v99, s61
  v_perm_b32 v255, v111, v107, s61
  v_mfma_f32_16x16x32_bf16 v[200:203], v[248:251], v[216:219], v[200:203]
  s_nop 1
  v_mfma_f32_16x16x32_bf16 v[204:207], v[252:255], v[216:219], v[204:207]
  s_waitcnt vmcnt(9)
  v_perm_b32 v240, v116, v112, s60
  v_perm_b32 v241, v124, v120, s60
  v_perm_b32 v242, v132, v128, s60
  v_perm_b32 v243, v140, v136, s60
  v_perm_b32 v244, v116, v112, s61
  v_perm_b32 v245, v124, v120, s61
  v_perm_b32 v246, v132, v128, s61
  v_perm_b32 v247, v140, v136, s61
  v_mfma_f32_16x16x32_bf16 v[176:179], v[240:243], v[220:223], v[176:179]
  v_perm_b32 v248, v117, v113, s60
  v_perm_b32 v249, v125, v121, s60
  v_perm_b32 v250, v133, v129, s60
  v_perm_b32 v251, v141, v137, s60
  v_mfma_f32_16x16x32_bf16 v[180:183], v[244:247], v[220:223], v[180:183]
  v_perm_b32 v252, v117, v113, s61
  v_perm_b32 v253, v125, v121, s61
  v_perm_b32 v254, v133, v129, s61
  v_perm_b32 v255, v141, v137, s61
  v_mfma_f32_16x16x32_bf16 v[184:187], v[248:251], v[220:223], v[184:187]
  v_perm_b32 v240, v118, v114, s60
  v_perm_b32 v241, v126, v122, s60
  v_perm_b32 v242, v134, v130, s60
  v_perm_b32 v243, v142, v138, s60
  v_mfma_f32_16x16x32_bf16 v[188:191], v[252:255], v[220:223], v[188:191]
  v_perm_b32 v244, v118, v114, s61
  v_perm_b32 v245, v126, v122, s61
  v_perm_b32 v246, v134, v130, s61
  v_perm_b32 v247, v142, v138, s61
  v_mfma_f32_16x16x32_bf16 v[192:195], v[240:243], v[220:223], v[192:195]
  v_perm_b32 v248, v119, v115, s60
  v_perm_b32 v249, v127, v123, s60
  v_perm_b32 v250, v135, v131, s60
  v_perm_b32 v251, v143, v139, s60
  v_mfma_f32_16x16x32_bf16 v[196:199], v[244:247], v[220:223], v[196:199]
  v_perm_b32 v252, v119, v115, s61
  v_perm_b32 v253, v127, v123, s61
  v_perm_b32 v254, v135, v131, s61
  v_perm_b32 v255, v143, v139, s61
  v_mfma_f32_16x16x32_bf16 v[200:203], v[248:251], v[220:223], v[200:203]
  s_nop 1
  v_mfma_f32_16x16x32_bf16 v[204:207], v[252:255], v[220:223], v[204:207]
  s_waitcnt vmcnt(1)
  v_perm_b32 v240, v148, v144, s60
  v_perm_b32 v241, v156, v152, s60
  v_perm_b32 v242, v164, v160, s60
  v_perm_b32 v243, v172, v168, s60
  v_perm_b32 v244, v148, v144, s61
  v_perm_b32 v245, v156, v152, s61
  v_perm_b32 v246, v164, v160, s61
  v_perm_b32 v247, v172, v168, s61
  v_mfma_f32_16x16x32_bf16 v[176:179], v[240:243], v[224:227], v[176:179]
  v_perm_b32 v248, v149, v145, s60
  v_perm_b32 v249, v157, v153, s60
  v_perm_b32 v250, v165, v161, s60
  v_perm_b32 v251, v173, v169, s60
  v_mfma_f32_16x16x32_bf16 v[180:183], v[244:247], v[224:227], v[180:183]
  v_perm_b32 v252, v149, v145, s61
  v_perm_b32 v253, v157, v153, s61
  v_perm_b32 v254, v165, v161, s61
  v_perm_b32 v255, v173, v169, s61
  v_mfma_f32_16x16x32_bf16 v[184:187], v[248:251], v[224:227], v[184:187]
  v_perm_b32 v240, v150, v146, s60
  v_perm_b32 v241, v158, v154, s60
  v_perm_b32 v242, v166, v162, s60
  v_perm_b32 v243, v174, v170, s60
  v_mfma_f32_16x16x32_bf16 v[188:191], v[252:255], v[224:227], v[188:191]
  v_perm_b32 v244, v150, v146, s61
  v_perm_b32 v245, v158, v154, s61
  v_perm_b32 v246, v166, v162, s61
  v_perm_b32 v247, v174, v170, s61
  v_mfma_f32_16x16x32_bf16 v[192:195], v[240:243], v[224:227], v[192:195]
  v_perm_b32 v248, v151, v147, s60
  v_perm_b32 v249, v159, v155, s60
  v_perm_b32 v250, v167, v163, s60
  v_perm_b32 v251, v175, v171, s60
  v_mfma_f32_16x16x32_bf16 v[196:199], v[244:247], v[224:227], v[196:199]
  v_perm_b32 v252, v151, v147, s61
  v_perm_b32 v253, v159, v155, s61
  v_perm_b32 v254, v167, v163, s61
  v_perm_b32 v255, v175, v171, s61
  v_mfma_f32_16x16x32_bf16 v[200:203], v[248:251], v[224:227], v[200:203]
  s_nop 1
  v_mfma_f32_16x16x32_bf16 v[204:207], v[252:255], v[224:227], v[204:207]
  s_mul_i32 s8, s9, 4224
  s_add_u32 s8, s8, 114688
  v_mul_u32_u24 v7, 528, v2
  v_lshl_add_u32 v7, v1, 7, v7
  v_add_u32 v7, s8, v7
  s_mov_b32 s10, 0x00ff00ff
  s_mov_b32 s11, 0x00ff00ff
  s_mov_b64 exec, s[10:11]
  ds_write_b128 v7, v[176:179] offset:0
  ds_write_b128 v7, v[180:183] offset:16
  ds_write_b128 v7, v[184:187] offset:32
  ds_write_b128 v7, v[188:191] offset:48
  ds_write_b128 v7, v[192:195] offset:64
  ds_write_b128 v7, v[196:199] offset:80
  ds_write_b128 v7, v[200:203] offset:96
  ds_write_b128 v7, v[204:207] offset:112
  s_mov_b64 exec, -1
  v_bfe_u32 v5, v0, 2, 3
  v_mul_u32_u24 v7, 528, v5
  v_and_b32 v8, 3, v0
  v_lshl_add_u32 v7, v8, 5, v7
  v_lshrrev_b32 v8, 5, v0
  v_lshl_add_u32 v7, v8, 2, v7
  s_lshl_b32 s8, s62, 7
  s_lshl_b32 s6, s63, 3
  s_add_u32 s8, s8, s6
  s_add_u32 s8, s8, 114688
  v_add_u32 v16, s8, v7
  v_add_u32 v17, 4224, v16
  v_add_u32 v18, 8448, v16
  v_add_u32 v19, 12672, v16
  v_lshlrev_b32 v20, 3, v5
  v_add_u32 v20, 147520, v20
  s_lshl_b32 s7, s56, 10
  s_lshl_b32 s8, s9, 8
  s_add_u32 s7, s7, s8
  s_add_u32 s7, s7, 0
  v_lshlrev_b32 v7, 2, v0
  s_waitcnt vmcnt(0) lgkmcnt(0)
  v_cmp_eq_u32 vcc, 0, v6
  s_and_b32 s8, vcc_lo, 15
  s_cbranch_scc0 L_pH_fl
  v_and_b32 v5, 7, v0
  v_lshlrev_b32 v5, 2, v5
  s_mov_b32 s10, 15
  s_mov_b32 s11, 0
fl_28:
  buffer_load_dword v6, v5, s[52:55], 0 offen sc1
  s_waitcnt vmcnt(0)
  v_cmp_eq_u32 vcc, 0, v6
  s_and_b64 vcc, vcc, s[10:11]
  s_cbranch_scc0 fle_29
  s_sleep 2
  s_sub_u32 s15, s15, 1
  s_cbranch_scc0 fl_28
  s_mov_b32 s15, 0
fle_29:
L_pH_fl:
  v_mov_b32 v10, 147488
  v_mov_b32 v11, 1
  s_mov_b64 exec, 1
  ds_add_u32 v10, v11
  s_mov_b64 exec, -1
  s_mov_b32 s58, 133333333
sp_30:
  ds_read_b32 v11, v10
  s_waitcnt lgkmcnt(0)
  v_readfirstlane_b32 s8, v11
  s_cmp_ge_u32 s8, 4
  s_cbranch_scc1 sp_30_ok
  s_sub_u32 s58, s58, 1
  s_cbranch_scc0 sp_30
sp_30_ok:
  ds_read_b64 v[8:9], v20
  ds_read2_b32 v[176:177], v16 offset0:0 offset1:4
  ds_read2_b32 v[178:179], v16 offset0:64 offset1:68
  ds_read2_b32 v[180:181], v17 offset0:0 offset1:4
  ds_read2_b32 v[182:183], v17 offset0:64 offset1:68
  ds_read2_b32 v[184:185], v18 offset0:0 offset1:4
  ds_read2_b32 v[186:187], v18 offset0:64 offset1:68
  ds_read2_b32 v[188:189], v19 offset0:0 offset1:4
  ds_read2_b32 v[190:191], v19 offset0:64 offset1:68
  v_lshlrev_b32 v10, 16, v237
  v_and_b32 v11, 0xffff0000, v237
  s_waitcnt lgkmcnt(8)
  v_sub_f32 v10, v10, v8
  v_sub_f32 v11, v11, v8
  v_cvt_pk_bf16_f32 v12, v10, v11
  v_lshlrev_b32 v10, 16, v12
  v_and_b32 v11, 0xffff0000, v12
  v_mul_f32 v10, v10, v9
  v_mul_f32 v11, v11, v9
  v_cvt_pk_bf16_f32 v12, v10, v11
  v_lshlrev_b32 v10, 16, v12
  v_and_b32 v11, 0xffff0000, v12
  s_waitcnt lgkmcnt(0)
  v_pk_add_f32 v[176:177], v[176:177], v[180:181]
  v_pk_add_f32 v[178:179], v[178:179], v[182:183]
  v_pk_add_f32 v[184:185], v[184:185], v[188:189]
  v_pk_add_f32 v[186:187], v[186:187], v[190:191]
  v_pk_add_f32 v[176:177], v[176:177], v[184:185]
  v_pk_add_f32 v[178:179], v[178:179], v[186:187]
  v_cvt_pk_bf16_f32 v12, v176, v177
  v_lshlrev_b32 v176, 16, v12
  v_and_b32 v177, 0xffff0000, v12
  v_cvt_pk_bf16_f32 v12, v178, v179
  v_lshlrev_b32 v178, 16, v12
  v_and_b32 v179, 0xffff0000, v12
  v_add_f32 v178, 1.0, v178
  v_add_f32 v179, 1.0, v179
  v_cvt_pk_bf16_f32 v12, v178, v179
  v_lshlrev_b32 v178, 16, v12
  v_and_b32 v179, 0xffff0000, v12
  v_mul_f32 v10, v10, v178
  v_mul_f32 v11, v11, v179
  v_cvt_pk_bf16_f32 v12, v10, v11
  v_lshlrev_b32 v10, 16, v12
  v_and_b32 v11, 0xffff0000, v12
  v_add_f32 v10, v10, v176
  v_add_f32 v11, v11, v177
  v_cvt_pk_bf16_f32 v10, v10, v11
  buffer_store_dword v10, v7, s[48:51], s7 offen sc1
  v_mov_b32 v10, 147492
  v_mov_b32 v11, 1
  s_mov_b64 exec, 1
  ds_add_u32 v10, v11
  s_mov_b64 exec, -1
  s_branch L_mid
L_p2:
  s_lshl_b32 s6, s4, 10
  s_sub_u32 s8, s5, 13
  s_lshl_b32 s8, s8, 7
  s_add_u32 s57, s6, s8
  s_mov_b32 s6, s57
  s_movk_i32 s7, 8192
  s_mov_b32 s44, s22
  s_mov_b32 s45, s23
  s_mov_b32 s46, 4718592
  s_mov_b32 s47, 0x20000
  s_mul_i32 s8, s9, 160
  s_min_u32 s8, s8, 448
  s_mul_i32 s8, s8, s7
  s_add_u32 s6, s6, s8
  s_lshl_b32 s8, s7, 3
  v_mul_lo_u32 v3, v1, s8
  v_lshl_add_u32 v3, v2, 3, v3
  buffer_load_dwordx2 v[32:33], v3, s[44:47], s6 offen
  s_add_u32 s6, s6, s7
  buffer_load_dwordx2 v[34:35], v3, s[44:47], s6 offen
  s_add_u32 s6, s6, s7
  buffer_load_dwordx2 v[36:37], v3, s[44:47], s6 offen
  s_add_u32 s6, s6, s7
  buffer_load_dwordx2 v[38:39], v3, s[44:47], s6 offen
  s_add_u32 s6, s6, s7
  buffer_load_dwordx2 v[40:41], v3, s[44:47], s6 offen
  s_add_u32 s6, s6, s7
  buffer_load_dwordx2 v[42:43], v3, s[44:47], s6 offen
  s_add_u32 s6, s6, s7
  buffer_load_dwordx2 v[44:45], v3, s[44:47], s6 offen
  s_add_u32 s6, s6, s7
  buffer_load_dwordx2 v[46:47], v3, s[44:47], s6 offen
  s_mul_i32 s8, s7, 25
  s_add_i32 s6, s6, s8
  buffer_load_dwordx2 v[48:49], v3, s[44:47], s6 offen
  s_add_u32 s6, s6, s7
  buffer_load_dwordx2 v[50:51], v3, s[44:47], s6 offen
  s_add_u32 s6, s6, s7
  buffer_load_dwordx2 v[52:53], v3, s[44:47], s6 offen
  s_add_u32 s6, s6, s7
  buffer_load_dwordx2 v[54:55], v3, s[44:47], s6 offen
  s_barrier
  s_add_u32 s6, s6, s7
  buffer_load_dwordx2 v[56:57], v3, s[44:47], s6 offen
  s_add_u32 s6, s6, s7
  buffer_load_dwordx2 v[58:59], v3, s[44:47], s6 offen
  s_add_u32 s6, s6, s7
  buffer_load_dwordx2 v[60:61], v3, s[44:47], s6 offen
  s_add_u32 s6, s6, s7
  buffer_load_dwordx2 v[62:63], v3, s[44:47], s6 offen
  s_mul_i32 s8, s7, 25
  s_add_i32 s6, s6, s8
  buffer_load_dwordx2 v[64:65], v3, s[44:47], s6 offen
  s_add_u32 s6, s6, s7
  buffer_load_dwordx2 v[66:67], v3, s[44:47], s6 offen
  s_add_u32 s6, s6, s7
  buffer_load_dwordx2 v[68:69], v3, s[44:47], s6 offen
  s_add_u32 s6, s6, s7
  buffer_load_dwordx2 v[70:71], v3, s[44:47], s6 offen
  s_add_u32 s6, s6, s7
  buffer_load_dwordx2 v[72:73], v3, s[44:47], s6 offen
  s_add_u32 s6, s6, s7
  buffer_load_dwordx2 v[74:75], v3, s[44:47], s6 offen
  s_add_u32 s6, s6, s7
  buffer_load_dwordx2 v[76:77], v3, s[44:47], s6 offen
  s_add_u32 s6, s6, s7
  buffer_load_dwordx2 v[78:79], v3, s[44:47], s6 offen
  s_mul_i32 s8, s7, 25
  s_add_i32 s6, s6, s8
  buffer_load_dwordx2 v[80:81], v3, s[44:47], s6 offen
  s_add_u32 s6, s6, s7
  buffer_load_dwordx2 v[82:83], v3, s[44:47], s6 offen
  s_add_u32 s6, s6, s7
  buffer_load_dwordx2 v[84:85], v3, s[44:47], s6 offen
  s_add_u32 s6, s6, s7
  buffer_load_dwordx2 v[86:87], v3, s[44:47], s6 offen
  s_add_u32 s6, s6, s7
  buffer_load_dwordx2 v[88:89], v3, s[44:47], s6 offen
  s_add_u32 s6, s6, s7
  buffer_load_dwordx2 v[90:91], v3, s[44:47], s6 offen
  s_add_u32 s6, s6, s7
  buffer_load_dwordx2 v[92:93], v3, s[44:47], s6 offen
  s_add_u32 s6, s6, s7
  buffer_load_dwordx2 v[94:95], v3, s[44:47], s6 offen
  s_mul_i32 s8, s7, 25
  s_add_i32 s6, s6, s8
  s_cmp_ge_u32 s9, 2
  s_cselect_b32 s46, 0, s46
  buffer_load_dwordx2 v[96:97], v3, s[44:47], s6 offen
  s_add_u32 s6, s6, s7
  buffer_load_dwordx2 v[98:99], v3, s[44:47], s6 offen
  s_add_u32 s6, s6, s7
  buffer_load_dwordx2 v[100:101], v3, s[44:47], s6 offen
  s_add_u32 s6, s6, s7
  buffer_load_dwordx2 v[102:103], v3, s[44:47], s6 offen
  s_add_u32 s6, s6, s7
  buffer_load_dwordx2 v[104:105], v3, s[44:47], s6 offen
  s_add_u32 s6, s6, s7
  buffer_load_dwordx2 v[106:107], v3, s[44:47], s6 offen
  s_add_u32 s6, s6, s7
  buffer_load_dwordx2 v[108:109], v3, s[44:47], s6 offen
  s_add_u32 s6, s6, s7
  buffer_load_dwordx2 v[110:111], v3, s[44:47], s6 offen
  v_mov_b32 v10, 147492
  v_mov_b32 v11, 1
  s_mov_b64 exec, 1
  ds_add_u32 v10, v11
  s_mov_b64 exec, -1
  s_waitcnt vmcnt(32)
  v_perm_b32 v16, v34, v32, s60
  v_perm_b32 v17, v38, v36, s60
  v_perm_b32 v18, v42, v40, s60
  v_perm_b32 v19, v46, v44, s60
  v_perm_b32 v20, v34, v32, s61
  v_perm_b32 v21, v38, v36, s61
  v_perm_b32 v22, v42, v40, s61
  v_perm_b32 v23, v46, v44, s61
  v_perm_b32 v24, v35, v33, s60
  v_perm_b32 v25, v39, v37, s60
  v_perm_b32 v26, v43, v41, s60
  v_perm_b32 v27, v47, v45, s60
  v_perm_b32 v28, v35, v33, s61
  v_perm_b32 v29, v39, v37, s61
  v_perm_b32 v30, v43, v41, s61
  v_perm_b32 v31, v47, v45, s61
  s_waitcnt vmcnt(24)
  v_perm_b32 v32, v50, v48, s60
  v_perm_b32 v33, v54, v52, s60
  v_perm_b32 v34, v58, v56, s60
  v_perm_b32 v35, v62, v60, s60
  v_perm_b32 v36, v50, v48, s61
  v_perm_b32 v37, v54, v52, s61
  v_perm_b32 v38, v58, v56, s61
  v_perm_b32 v39, v62, v60, s61
  v_perm_b32 v40, v51, v49, s60
  v_perm_b32 v41, v55, v53, s60
  v_perm_b32 v42, v59, v57, s60
  v_perm_b32 v43, v63, v61, s60
  v_perm_b32 v44, v51, v49, s61
  v_perm_b32 v45, v55, v53, s61
  v_perm_b32 v46, v59, v57, s61
  v_perm_b32 v47, v63, v61, s61
  s_waitcnt vmcnt(16)
  v_perm_b32 v48, v66, v64, s60
  v_perm_b32 v49, v70, v68, s60
  v_perm_b32 v50, v74, v72, s60
  v_perm_b32 v51, v78, v76, s60
  v_perm_b32 v52, v66, v64, s61
  v_perm_b32 v53, v70, v68, s61
  v_perm_b32 v54, v74, v72, s61
  v_perm_b32 v55, v78, v76, s61
  v_perm_b32 v56, v67, v65, s60
  v_perm_b32 v57, v71, v69, s60
  v_perm_b32 v58, v75, v73, s60
  v_perm_b32 v59, v79, v77, s60
  v_perm_b32 v60, v67, v65, s61
  v_perm_b32 v61, v71, v69, s61
  v_perm_b32 v62, v75, v73, s61
  v_perm_b32 v63, v79, v77, s61
  s_waitcnt vmcnt(8)
  v_perm_b32 v64, v82, v80, s60
  v_perm_b32 v65, v86, v84, s60
  v_perm_b32 v66, v90, v88, s60
  v_perm_b32 v67, v94, v92, s60
  v_perm_b32 v68, v82, v80, s61
  v_perm_b32 v69, v86, v84, s61
  v_perm_b32 v70, v90, v88, s61
  v_perm_b32 v71, v94, v92, s61
  v_perm_b32 v72, v83, v81, s60
  v_perm_b32 v73, v87, v85, s60
  v_perm_b32 v74, v91, v89, s60
  v_perm_b32 v75, v95, v93, s60
  v_perm_b32 v76, v83, v81, s61
  v_perm_b32 v77, v87, v85, s61
  v_perm_b32 v78, v91, v89, s61
  v_perm_b32 v79, v95, v93, s61
  s_waitcnt vmcnt(0)
  v_perm_b32 v80, v98, v96, s60
  v_perm_b32 v81, v102, v100, s60
  v_perm_b32 v82, v106, v104, s60
  v_perm_b32 v83, v110, v108, s60
  v_perm_b32 v84, v98, v96, s61
  v_perm_b32 v85, v102, v100, s61
  v_perm_b32 v86, v106, v104, s61
  v_perm_b32 v87, v110, v108, s61
  v_perm_b32 v88, v99, v97, s60
  v_perm_b32 v89, v103, v101, s60
  v_perm_b32 v90, v107, v105, s60
  v_perm_b32 v91, v111, v109, s60
  v_perm_b32 v92, v99, v97, s61
  v_perm_b32 v93, v103, v101, s61
  v_perm_b32 v94, v107, v105, s61
  v_perm_b32 v95, v111, v109, s61
  v_and_b32 v5, 7, v0
  v_lshlrev_b32 v5, 2, v5
  s_mov_b32 s10, 15
  s_mov_b32 s11, 0
fl_31:
  buffer_load_dword v6, v5, s[52:55], 0 offen sc1
  s_waitcnt vmcnt(0)
  v_cmp_eq_u32 vcc, 0, v6
  s_and_b64 vcc, vcc, s[10:11]
  s_cbranch_scc0 fle_32
  s_sleep 2
  s_sub_u32 s15, s15, 1
  s_cbranch_scc0 fl_31
  s_mov_b32 s15, 0
fle_32:
  s_mov_b32 s6, 0
  v_and_b32 v4, 7, v0
  v_lshlrev_b32 v4, 4, v4
  v_lshl_add_u32 v4, v1, 7, v4
  v_bfe_u32 v5, v0, 3, 1
  v_lshl_add_u32 v5, v5, 9, v4
  s_mul_i32 s8, s9, 2560
  s_min_u32 s8, s8, 7168
  s_add_u32 s6, s6, s8
  s_cmp_ge_u32 s9, 2
  s_cselect_b32 s8, 0, 2048
  s_add_u32 s7, s6, s8
  v_lshrrev_b32 v7, 5, v0
  v_lshlrev_b32 v7, 13, v7
  v_and_b32 v8, 31, v0
  v_lshl_add_u32 v7, v8, 2, v7
  s_lshl_b32 s8, s9, 14
  s_add_u32 s57, s57, s8
  s_add_u32 s57, s57, 9216
po_33:
  buffer_load_dwordx4 v[176:179], v5, s[48:51], s6 offen offset:0 sc1
  buffer_load_dwordx4 v[184:187], v5, s[48:51], s6 offen offset:1024 sc1
  buffer_load_dwordx4 v[192:195], v4, s[48:51], s7 offen sc1
  s_waitcnt vmcnt(2)
  v_max3_u32 v6, v176, v177, v178
  v_max_u32 v6, v6, v179
  s_waitcnt vmcnt(1)
  v_max3_u32 v6, v6, v184, v185
  v_max3_u32 v6, v6, v186, v187
  s_waitcnt vmcnt(0)
  v_max3_u32 v6, v6, v192, v193
  v_max3_u32 v6, v6, v194, v195
  v_cmp_eq_u32 vcc, -1, v6
  s_cbranch_vccz poe_34
  s_sub_u32 s15, s15, 1
  s_cbranch_scc0 po_33
  s_mov_b32 s15, 0
poe_34:
  v_mov_b32 v180, v176 row_ror:8 row_mask:0xf bank_mask:0xf
  v_mov_b32 v181, v177 row_ror:8 row_mask:0xf bank_mask:0xf
  v_mov_b32 v182, v178 row_ror:8 row_mask:0xf bank_mask:0xf
  v_mov_b32 v183, v179 row_ror:8 row_mask:0xf bank_mask:0xf
  v_mfma_f32_16x16x32_bf16 v[212:215], v[16:19], v[176:179], 0
  v_mfma_f32_16x16x32_bf16 v[216:219], v[20:23], v[176:179], 0
  v_mfma_f32_16x16x32_bf16 v[220:223], v[24:27], v[176:179], 0
  v_mfma_f32_16x16x32_bf16 v[224:227], v[28:31], v[176:179], 0
  v_mfma_f32_16x16x32_bf16 v[212:215], v[32:35], v[180:183], v[212:215]
  v_mfma_f32_16x16x32_bf16 v[216:219], v[36:39], v[180:183], v[216:219]
  v_mfma_f32_16x16x32_bf16 v[220:223], v[40:43], v[180:183], v[220:223]
  v_mfma_f32_16x16x32_bf16 v[224:227], v[44:47], v[180:183], v[224:227]
  v_mov_b32 v188, v184 row_ror:8 row_mask:0xf bank_mask:0xf
  v_mov_b32 v189, v185 row_ror:8 row_mask:0xf bank_mask:0xf
  v_mov_b32 v190, v186 row_ror:8 row_mask:0xf bank_mask:0xf
  v_mov_b32 v191, v187 row_ror:8 row_mask:0xf bank_mask:0xf
  v_mfma_f32_16x16x32_bf16 v[212:215], v[48:51], v[184:187], v[212:215]
  v_mfma_f32_16x16x32_bf16 v[216:219], v[52:55], v[184:187], v[216:219]
  v_mfma_f32_16x16x32_bf16 v[220:223], v[56:59], v[184:187], v[220:223]
  v_mfma_f32_16x16x32_bf16 v[224:227], v[60:63], v[184:187], v[224:227]
  v_mfma_f32_16x16x32_bf16 v[212:215], v[64:67], v[188:191], v[212:215]
  v_mfma_f32_16x16x32_bf16 v[216:219], v[68:71], v[188:191], v[216:219]
  v_mfma_f32_16x16x32_bf16 v[220:223], v[72:75], v[188:191], v[220:223]
  v_mfma_f32_16x16x32_bf16 v[224:227], v[76:79], v[188:191], v[224:227]
  v_mfma_f32_16x16x32_bf16 v[212:215], v[80:83], v[192:195], v[212:215]
  v_mfma_f32_16x16x32_bf16 v[216:219], v[84:87], v[192:195], v[216:219]
  v_mfma_f32_16x16x32_bf16 v[220:223], v[88:91], v[192:195], v[220:223]
  v_mfma_f32_16x16x32_bf16 v[224:227], v[92:95], v[192:195], v[224:227]
  s_nop 4
  s_mov_b32 s10, 0x00ff00ff
  s_mov_b32 s11, 0x00ff00ff
  s_mov_b64 exec, s[10:11]
  ds_write_b128 v13, v[212:215] offset:0
  ds_write_b128 v13, v[216:219] offset:16
  ds_write_b128 v13, v[220:223] offset:32
  ds_write_b128 v13, v[224:227] offset:48
  s_mov_b64 exec, -1
  s_waitcnt lgkmcnt(0)
  v_mov_b32 v10, 147488
  v_mov_b32 v11, 1
  s_mov_b64 exec, 1
  ds_add_u32 v10, v11
  s_mov_b64 exec, -1
  s_mov_b32 s58, 133333333
sp_35:
  ds_read_b32 v11, v10
  s_waitcnt lgkmcnt(0)
  v_readfirstlane_b32 s8, v11
  s_cmp_ge_u32 s8, 4
  s_cbranch_scc1 sp_35_ok
  s_sub_u32 s58, s58, 1
  s_cbranch_scc0 sp_35
sp_35_ok:
  ds_read_b32 v212, v15 offset:0
  ds_read_b32 v213, v15 offset:16
  ds_read_b32 v214, v15 offset:2176
  ds_read_b32 v215, v15 offset:2192
  ds_read_b32 v216, v15 offset:4352
  ds_read_b32 v217, v15 offset:4368
  ds_read_b32 v218, v15 offset:6528
  ds_read_b32 v219, v15 offset:6544
  s_waitcnt lgkmcnt(4)
  v_add_f32 v212, v212, v214
  v_add_f32 v213, v213, v215
  s_waitcnt lgkmcnt(0)
  v_add_f32 v216, v216, v218
  v_add_f32 v217, v217, v219
  v_add_f32 v10, v212, v216
  v_add_f32 v11, v213, v217
  v_cvt_pk_bf16_f32 v10, v10, v11
  buffer_store_dword v10, v7, s[48:51], s57 offen
  v_mov_b32 v11, 147472
  s_mov_b32 s58, 16
sp_36:
  ds_read_b32 v12, v11
  s_waitcnt lgkmcnt(0)
  v_readfirstlane_b32 s8, v12
  s_cmp_ge_u32 s8, 7
  s_cbranch_scc1 sp_36_ok
  s_sleep 8
  s_sub_u32 s58, s58, 1
  s_cbranch_scc0 sp_36
sp_36_ok:
  buffer_store_dword v10, v7, s[48:51], s57 offen sc1
L_mid:
  s_cmp_lt_u32 s5, 9
  s_cbranch_scc1 L_midF
  s_cmp_lt_u32 s5, 13
  s_cbranch_scc1 L_midM
  s_cmp_lt_u32 s5, 22
  s_cbranch_scc1 L_midD
  s_cmp_ge_u32 s5, 31
  s_cbranch_scc1 L_mid2
  s_mov_b32 s44, s24
  s_mov_b32 s45, s25
  s_mov_b32 s46, 4718592
  s_mov_b32 s47, 0x20000
  s_lshl_b32 s6, s4, 2
  s_add_u32 s6, s6, s9
  s_mul_i32 s6, s6, 147456
  s_sub_u32 s8, s5, 22
  s_lshl_b32 s8, s8, 7
  s_add_u32 s6, s6, s8
  s_movk_i32 s7, 1152
  v_mul_u32_u24 v3, 2304, v1
  v_lshl_add_u32 v3, v2, 3, v3
  buffer_load_dwordx2 v[32:33], v3, s[44:47], s6 offen nt
  s_mul_i32 s8, s7, 8
  s_add_i32 s6, s6, s8
  buffer_load_dwordx2 v[34:35], v3, s[44:47], s6 offen nt
  s_mul_i32 s8, s7, 8
  s_add_i32 s6, s6, s8
  buffer_load_dwordx2 v[36:37], v3, s[44:47], s6 offen nt
  s_mul_i32 s8, s7, 8
  s_add_i32 s6, s6, s8
  buffer_load_dwordx2 v[38:39], v3, s[44:47], s6 offen nt
  s_mul_i32 s8, s7, -23
  s_add_i32 s6, s6, s8
  buffer_load_dwordx2 v[40:41], v3, s[44:47], s6 offen nt
  s_waitcnt vmcnt(4)
  s_mul_i32 s8, s7, 8
  s_add_i32 s6, s6, s8
  buffer_load_dwordx2 v[42:43], v3, s[44:47], s6 offen nt
  s_waitcnt vmcnt(4)
  s_mul_i32 s8, s7, 8
  s_add_i32 s6, s6, s8
  buffer_load_dwordx2 v[44:45], v3, s[44:47], s6 offen nt
  s_waitcnt vmcnt(4)
  s_mul_i32 s8, s7, 8
  s_add_i32 s6, s6, s8
  buffer_load_dwordx2 v[46:47], v3, s[44:47], s6 offen nt
  s_waitcnt vmcnt(4)
  s_mul_i32 s8, s7, 7
  s_add_i32 s6, s6, s8
  buffer_load_dwordx2 v[48:49], v3, s[44:47], s6 offen nt
  s_waitcnt vmcnt(4)
  s_mul_i32 s8, s7, 8
  s_add_i32 s6, s6, s8
  buffer_load_dwordx2 v[50:51], v3, s[44:47], s6 offen nt
  s_waitcnt vmcnt(4)
  s_mul_i32 s8, s7, 8
  s_add_i32 s6, s6, s8
  buffer_load_dwordx2 v[52:53], v3, s[44:47], s6 offen nt
  s_waitcnt vmcnt(4)
  s_mul_i32 s8, s7, 8
  s_add_i32 s6, s6, s8
  buffer_load_dwordx2 v[54:55], v3, s[44:47], s6 offen nt
  s_waitcnt vmcnt(4)
  s_mul_i32 s8, s7, -23
  s_add_i32 s6, s6, s8
  buffer_load_dwordx2 v[56:57], v3, s[44:47], s6 offen nt
  s_waitcnt vmcnt(4)
  s_mul_i32 s8, s7, 8
  s_add_i32 s6, s6, s8
  buffer_load_dwordx2 v[58:59], v3, s[44:47], s6 offen nt
  s_waitcnt vmcnt(4)
  s_mul_i32 s8, s7, 8
  s_add_i32 s6, s6, s8
  buffer_load_dwordx2 v[60:61], v3, s[44:47], s6 offen nt
  s_waitcnt vmcnt(4)
  s_mul_i32 s8, s7, 8
  s_add_i32 s6, s6, s8
  buffer_load_dwordx2 v[62:63], v3, s[44:47], s6 offen nt
  s_waitcnt vmcnt(4)
  s_mul_i32 s8, s7, 7
  s_add_i32 s6, s6, s8
  buffer_load_dwordx2 v[64:65], v3, s[44:47], s6 offen nt
  s_waitcnt vmcnt(4)
  s_mul_i32 s8, s7, 8
  s_add_i32 s6, s6, s8
  buffer_load_dwordx2 v[66:67], v3, s[44:47], s6 offen nt
  s_waitcnt vmcnt(4)
  s_mul_i32 s8, s7, 8
  s_add_i32 s6, s6, s8
  buffer_load_dwordx2 v[68:69], v3, s[44:47], s6 offen nt
  s_waitcnt vmcnt(4)
  s_mul_i32 s8, s7, 8
  s_add_i32 s6, s6, s8
  buffer_load_dwordx2 v[70:71], v3, s[44:47], s6 offen nt
  s_waitcnt vmcnt(4)
  s_mul_i32 s8, s7, -23
  s_add_i32 s6, s6, s8
  buffer_load_dwordx2 v[72:73], v3, s[44:47], s6 offen nt
  s_waitcnt vmcnt(4)
  s_mul_i32 s8, s7, 8
  s_add_i32 s6, s6, s8
  buffer_load_dwordx2 v[74:75], v3, s[44:47], s6 offen nt
  s_waitcnt vmcnt(4)
  s_mul_i32 s8, s7, 8
  s_add_i32 s6, s6, s8
  buffer_load_dwordx2 v[76:77], v3, s[44:47], s6 offen nt
  s_waitcnt vmcnt(4)
  s_mul_i32 s8, s7, 8
  s_add_i32 s6, s6, s8
  buffer_load_dwordx2 v[78:79], v3, s[44:47], s6 offen nt
  s_waitcnt vmcnt(4)
  s_mul_i32 s8, s7, 7
  s_add_i32 s6, s6, s8
  buffer_load_dwordx2 v[80:81], v3, s[44:47], s6 offen nt
  s_waitcnt vmcnt(4)
  s_mul_i32 s8, s7, 8
  s_add_i32 s6, s6, s8
  buffer_load_dwordx2 v[82:83], v3, s[44:47], s6 offen nt
  s_waitcnt vmcnt(4)
  s_mul_i32 s8, s7, 8
  s_add_i32 s6, s6, s8
  buffer_load_dwordx2 v[84:85], v3, s[44:47], s6 offen nt
  s_waitcnt vmcnt(4)
  s_mul_i32 s8, s7, 8
  s_add_i32 s6, s6, s8
  buffer_load_dwordx2 v[86:87], v3, s[44:47], s6 offen nt
  s_waitcnt vmcnt(4)
  s_mul_i32 s8, s7, -23
  s_add_i32 s6, s6, s8
  buffer_load_dwordx2 v[88:89], v3, s[44:47], s6 offen nt
  s_waitcnt vmcnt(4)
  s_mul_i32 s8, s7, 8
  s_add_i32 s6, s6, s8
  buffer_load_dwordx2 v[90:91], v3, s[44:47], s6 offen nt
  s_waitcnt vmcnt(4)
  s_mul_i32 s8, s7, 8
  s_add_i32 s6, s6, s8
  buffer_load_dwordx2 v[92:93], v3, s[44:47], s6 offen nt
  s_waitcnt vmcnt(4)
  s_mul_i32 s8, s7, 8
  s_add_i32 s6, s6, s8
  buffer_load_dwordx2 v[94:95], v3, s[44:47], s6 offen nt
  s_waitcnt vmcnt(24)
  v_perm_b32 v16, v34, v32, s60
  v_perm_b32 v17, v38, v36, s60
  v_perm_b32 v18, v42, v40, s60
  v_perm_b32 v19, v46, v44, s60
  v_perm_b32 v20, v34, v32, s61
  v_perm_b32 v21, v38, v36, s61
  v_perm_b32 v22, v42, v40, s61
  v_perm_b32 v23, v46, v44, s61
  v_perm_b32 v24, v35, v33, s60
  v_perm_b32 v25, v39, v37, s60
  v_perm_b32 v26, v43, v41, s60
  v_perm_b32 v27, v47, v45, s60
  v_perm_b32 v28, v35, v33, s61
  v_perm_b32 v29, v39, v37, s61
  v_perm_b32 v30, v43, v41, s61
  v_perm_b32 v31, v47, v45, s61
  s_waitcnt vmcnt(16)
  v_perm_b32 v32, v50, v48, s60
  v_perm_b32 v33, v54, v52, s60
  v_perm_b32 v34, v58, v56, s60
  v_perm_b32 v35, v62, v60, s60
  v_perm_b32 v36, v50, v48, s61
  v_perm_b32 v37, v54, v52, s61
  v_perm_b32 v38, v58, v56, s61
  v_perm_b32 v39, v62, v60, s61
  v_perm_b32 v40, v51, v49, s60
  v_perm_b32 v41, v55, v53, s60
  v_perm_b32 v42, v59, v57, s60
  v_perm_b32 v43, v63, v61, s60
  v_perm_b32 v44, v51, v49, s61
  v_perm_b32 v45, v55, v53, s61
  v_perm_b32 v46, v59, v57, s61
  v_perm_b32 v47, v63, v61, s61
  s_waitcnt vmcnt(8)
  v_perm_b32 v48, v66, v64, s60
  v_perm_b32 v49, v70, v68, s60
  v_perm_b32 v50, v74, v72, s60
  v_perm_b32 v51, v78, v76, s60
  v_perm_b32 v52, v66, v64, s61
  v_perm_b32 v53, v70, v68, s61
  v_perm_b32 v54, v74, v72, s61
  v_perm_b32 v55, v78, v76, s61
  v_perm_b32 v56, v67, v65, s60
  v_perm_b32 v57, v71, v69, s60
  v_perm_b32 v58, v75, v73, s60
  v_perm_b32 v59, v79, v77, s60
  v_perm_b32 v60, v67, v65, s61
  v_perm_b32 v61, v71, v69, s61
  v_perm_b32 v62, v75, v73, s61
  v_perm_b32 v63, v79, v77, s61
  s_waitcnt vmcnt(0)
  v_perm_b32 v64, v82, v80, s60
  v_perm_b32 v65, v86, v84, s60
  v_perm_b32 v66, v90, v88, s60
  v_perm_b32 v67, v94, v92, s60
  v_perm_b32 v68, v82, v80, s61
  v_perm_b32 v69, v86, v84, s61
  v_perm_b32 v70, v90, v88, s61
  v_perm_b32 v71, v94, v92, s61
  v_perm_b32 v72, v83, v81, s60
  v_perm_b32 v73, v87, v85, s60
  v_perm_b32 v74, v91, v89, s60
  v_perm_b32 v75, v95, v93, s60
  v_perm_b32 v76, v83, v81, s61
  v_perm_b32 v77, v87, v85, s61
  v_perm_b32 v78, v91, v89, s61
  v_perm_b32 v79, v95, v93, s61
  s_branch L_mid2
L_midD:
  s_branch L_mid2
L_midM:
  s_sub_u32 s56, s2, 81
  s_cmp_ge_u32 s56, 18
  s_cbranch_scc1 L_mid2
  s_cmp_ge_u32 s56, 9
  s_cselect_b32 s57, 2, 1
  s_cselect_b32 s8, 9, 0
  s_sub_u32 s56, s56, s8
  s_lshl_b32 s8, s57, 1
  s_add_u32 s8, s8, s62
  s_lshl_b32 s8, s8, 2
  s_lshr_b32 s8, 0x524310, s8
  s_and_b32 s8, s8, 7
  s_mul_i32 s6, s8, 1152
  s_lshl_b32 s8, s56, 7
  s_add_u32 s6, s6, s8
  s_movk_i32 s7, 6912
  s_mov_b32 s44, s34
  s_mov_b32 s45, s35
  s_mov_b32 s46, 9216
  s_mov_b32 s47, 0x20000
  v_and_b32 v5, 7, v0
  v_mul_u32_u24 v5, 1152, v5
  v_lshl_add_u32 v5, v1, 4, v5
  v_bfe_u32 v6, v0, 3, 1
  v_lshl_add_u32 v5, v6, 6, v5
  s_mul_i32 s8, s63, 576
  buffer_load_dwordx4 v[176:179], v5, s[44:47], s8 offen offset:0
  buffer_load_dwordx4 v[184:187], v5, s[44:47], s8 offen offset:128
  buffer_load_dwordx4 v[192:195], v5, s[44:47], s8 offen offset:256
  buffer_load_dwordx4 v[200:203], v5, s[44:47], s8 offen offset:384
  buffer_load_dwordx4 v[208:211], v5, s[44:47], s8 offen offset:512
  s_waitcnt vmcnt(0)
  v_lshlrev_b32 v16, 16, v176
  v_and_b32 v17, 0xffff0000, v176
  v_lshlrev_b32 v18, 16, v177
  v_and_b32 v19, 0xffff0000, v177
  v_lshlrev_b32 v20, 16, v178
  v_and_b32 v21, 0xffff0000, v178
  v_lshlrev_b32 v22, 16, v179
  v_and_b32 v23, 0xffff0000, v179
  v_max_f32 v16, 0xc2ae0000, v16
  v_max_f32 v17, 0xc2ae0000, v17
  v_max_f32 v18, 0xc2ae0000, v18
  v_max_f32 v19, 0xc2ae0000, v19
  v_max_f32 v20, 0xc2ae0000, v20
  v_max_f32 v21, 0xc2ae0000, v21
  v_max_f32 v22, 0xc2ae0000, v22
  v_max_f32 v23, 0xc2ae0000, v23
  v_mul_f32 v24, 0xbfb8aa3b, v16
  v_mul_f32 v25, 0xbfb8aa3b, v17
  v_mul_f32 v26, 0xbfb8aa3b, v18
  v_mul_f32 v27, 0xbfb8aa3b, v19
  v_mul_f32 v28, 0xbfb8aa3b, v20
  v_mul_f32 v29, 0xbfb8aa3b, v21
  v_mul_f32 v30, 0xbfb8aa3b, v22
  v_mul_f32 v31, 0xbfb8aa3b, v23
  v_exp_f32 v24, v24
  v_exp_f32 v25, v25
  v_exp_f32 v26, v26
  v_exp_f32 v27, v27
  v_exp_f32 v28, v28
  v_exp_f32 v29, v29
  v_exp_f32 v30, v30
  v_exp_f32 v31, v31
  v_add_f32 v24, 1.0, v24
  v_add_f32 v25, 1.0, v25
  v_add_f32 v26, 1.0, v26
  v_add_f32 v27, 1.0, v27
  v_add_f32 v28, 1.0, v28
  v_add_f32 v29, 1.0, v29
  v_add_f32 v30, 1.0, v30
  v_add_f32 v31, 1.0, v31
  v_rcp_f32 v212, v24
  v_rcp_f32 v213, v25
  v_rcp_f32 v214, v26
  v_rcp_f32 v215, v27
  v_rcp_f32 v216, v28
  v_rcp_f32 v217, v29
  v_rcp_f32 v218, v30
  v_rcp_f32 v219, v31
  v_mul_f32 v220, v16, v212
  v_mul_f32 v221, v17, v213
  v_mul_f32 v222, v18, v214
  v_mul_f32 v223, v19, v215
  v_mul_f32 v224, v20, v216
  v_mul_f32 v225, v21, v217
  v_mul_f32 v226, v22, v218
  v_mul_f32 v227, v23, v219
  v_fma_f32 v24, -v220, v24, v16
  v_fma_f32 v25, -v221, v25, v17
  v_fma_f32 v26, -v222, v26, v18
  v_fma_f32 v27, -v223, v27, v19
  v_fma_f32 v28, -v224, v28, v20
  v_fma_f32 v29, -v225, v29, v21
  v_fma_f32 v30, -v226, v30, v22
  v_fma_f32 v31, -v227, v31, v23
  v_fma_f32 v16, v24, v212, v220
  v_fma_f32 v17, v25, v213, v221
  v_fma_f32 v18, v26, v214, v222
  v_fma_f32 v19, v27, v215, v223
  v_fma_f32 v20, v28, v216, v224
  v_fma_f32 v21, v29, v217, v225
  v_fma_f32 v22, v30, v218, v226
  v_fma_f32 v23, v31, v219, v227
  v_cvt_pk_bf16_f32 v176, v16, v17
  v_cvt_pk_bf16_f32 v177, v18, v19
  v_cvt_pk_bf16_f32 v178, v20, v21
  v_cvt_pk_bf16_f32 v179, v22, v23
  s_nop 0
  v_mov_b32 v180, v176 row_ror:8 row_mask:0xf bank_mask:0xf
  v_mov_b32 v181, v177 row_ror:8 row_mask:0xf bank_mask:0xf
  v_mov_b32 v182, v178 row_ror:8 row_mask:0xf bank_mask:0xf
  v_mov_b32 v183, v179 row_ror:8 row_mask:0xf bank_mask:0xf
  v_lshlrev_b32 v16, 16, v184
  v_and_b32 v17, 0xffff0000, v184
  v_lshlrev_b32 v18, 16, v185
  v_and_b32 v19, 0xffff0000, v185
  v_lshlrev_b32 v20, 16, v186
  v_and_b32 v21, 0xffff0000, v186
  v_lshlrev_b32 v22, 16, v187
  v_and_b32 v23, 0xffff0000, v187
  v_max_f32 v16, 0xc2ae0000, v16
  v_max_f32 v17, 0xc2ae0000, v17
  v_max_f32 v18, 0xc2ae0000, v18
  v_max_f32 v19, 0xc2ae0000, v19
  v_max_f32 v20, 0xc2ae0000, v20
  v_max_f32 v21, 0xc2ae0000, v21
  v_max_f32 v22, 0xc2ae0000, v22
  v_max_f32 v23, 0xc2ae0000, v23
  v_mul_f32 v24, 0xbfb8aa3b, v16
  v_mul_f32 v25, 0xbfb8aa3b, v17
  v_mul_f32 v26, 0xbfb8aa3b, v18
  v_mul_f32 v27, 0xbfb8aa3b, v19
  v_mul_f32 v28, 0xbfb8aa3b, v20
  v_mul_f32 v29, 0xbfb8aa3b, v21
  v_mul_f32 v30, 0xbfb8aa3b, v22
  v_mul_f32 v31, 0xbfb8aa3b, v23
  v_exp_f32 v24, v24
  v_exp_f32 v25, v25
  v_exp_f32 v26, v26
  v_exp_f32 v27, v27
  v_exp_f32 v28, v28
  v_exp_f32 v29, v29
  v_exp_f32 v30, v30
  v_exp_f32 v31, v31
  v_add_f32 v24, 1.0, v24
  v_add_f32 v25, 1.0, v25
  v_add_f32 v26, 1.0, v26
  v_add_f32 v27, 1.0, v27
  v_add_f32 v28, 1.0, v28
  v_add_f32 v29, 1.0, v29
  v_add_f32 v30, 1.0, v30
  v_add_f32 v31, 1.0, v31
  v_rcp_f32 v212, v24
  v_rcp_f32 v213, v25
  v_rcp_f32 v214, v26
  v_rcp_f32 v215, v27
  v_rcp_f32 v216, v28
  v_rcp_f32 v217, v29
  v_rcp_f32 v218, v30
  v_rcp_f32 v219, v31
  v_mul_f32 v220, v16, v212
  v_mul_f32 v221, v17, v213
  v_mul_f32 v222, v18, v214
  v_mul_f32 v223, v19, v215
  v_mul_f32 v224, v20, v216
  v_mul_f32 v225, v21, v217
  v_mul_f32 v226, v22, v218
  v_mul_f32 v227, v23, v219
  v_fma_f32 v24, -v220, v24, v16
  v_fma_f32 v25, -v221, v25, v17
  v_fma_f32 v26, -v222, v26, v18
  v_fma_f32 v27, -v223, v27, v19
  v_fma_f32 v28, -v224, v28, v20
  v_fma_f32 v29, -v225, v29, v21
  v_fma_f32 v30, -v226, v30, v22
  v_fma_f32 v31, -v227, v31, v23
  v_fma_f32 v16, v24, v212, v220
  v_fma_f32 v17, v25, v213, v221
  v_fma_f32 v18, v26, v214, v222
  v_fma_f32 v19, v27, v215, v223
  v_fma_f32 v20, v28, v216, v224
  v_fma_f32 v21, v29, v217, v225
  v_fma_f32 v22, v30, v218, v226
  v_fma_f32 v23, v31, v219, v227
  v_cvt_pk_bf16_f32 v184, v16, v17
  v_cvt_pk_bf16_f32 v185, v18, v19
  v_cvt_pk_bf16_f32 v186, v20, v21
  v_cvt_pk_bf16_f32 v187, v22, v23
  s_nop 0
  v_mov_b32 v188, v184 row_ror:8 row_mask:0xf bank_mask:0xf
  v_mov_b32 v189, v185 row_ror:8 row_mask:0xf bank_mask:0xf
  v_mov_b32 v190, v186 row_ror:8 row_mask:0xf bank_mask:0xf
  v_mov_b32 v191, v187 row_ror:8 row_mask:0xf bank_mask:0xf
  v_lshlrev_b32 v16, 16, v192
  v_and_b32 v17, 0xffff0000, v192
  v_lshlrev_b32 v18, 16, v193
  v_and_b32 v19, 0xffff0000, v193
  v_lshlrev_b32 v20, 16, v194
  v_and_b32 v21, 0xffff0000, v194
  v_lshlrev_b32 v22, 16, v195
  v_and_b32 v23, 0xffff0000, v195
  v_max_f32 v16, 0xc2ae0000, v16
  v_max_f32 v17, 0xc2ae0000, v17
  v_max_f32 v18, 0xc2ae0000, v18
  v_max_f32 v19, 0xc2ae0000, v19
  v_max_f32 v20, 0xc2ae0000, v20
  v_max_f32 v21, 0xc2ae0000, v21
  v_max_f32 v22, 0xc2ae0000, v22
  v_max_f32 v23, 0xc2ae0000, v23
  v_mul_f32 v24, 0xbfb8aa3b, v16
  v_mul_f32 v25, 0xbfb8aa3b, v17
  v_mul_f32 v26, 0xbfb8aa3b, v18
  v_mul_f32 v27, 0xbfb8aa3b, v19
  v_mul_f32 v28, 0xbfb8aa3b, v20
  v_mul_f32 v29, 0xbfb8aa3b, v21
  v_mul_f32 v30, 0xbfb8aa3b, v22
  v_mul_f32 v31, 0xbfb8aa3b, v23
  v_exp_f32 v24, v24
  v_exp_f32 v25, v25
  v_exp_f32 v26, v26
  v_exp_f32 v27, v27
  v_exp_f32 v28, v28
  v_exp_f32 v29, v29
  v_exp_f32 v30, v30
  v_exp_f32 v31, v31
  v_add_f32 v24, 1.0, v24
  v_add_f32 v25, 1.0, v25
  v_add_f32 v26, 1.0, v26
  v_add_f32 v27, 1.0, v27
  v_add_f32 v28, 1.0, v28
  v_add_f32 v29, 1.0, v29
  v_add_f32 v30, 1.0, v30
  v_add_f32 v31, 1.0, v31
  v_rcp_f32 v212, v24
  v_rcp_f32 v213, v25
  v_rcp_f32 v214, v26
  v_rcp_f32 v215, v27
  v_rcp_f32 v216, v28
  v_rcp_f32 v217, v29
  v_rcp_f32 v218, v30
  v_rcp_f32 v219, v31
  v_mul_f32 v220, v16, v212
  v_mul_f32 v221, v17, v213
  v_mul_f32 v222, v18, v214
  v_mul_f32 v223, v19, v215
  v_mul_f32 v224, v20, v216
  v_mul_f32 v225, v21, v217
  v_mul_f32 v226, v22, v218
  v_mul_f32 v227, v23, v219
  v_fma_f32 v24, -v220, v24, v16
  v_fma_f32 v25, -v221, v25, v17
  v_fma_f32 v26, -v222, v26, v18
  v_fma_f32 v27, -v223, v27, v19
  v_fma_f32 v28, -v224, v28, v20
  v_fma_f32 v29, -v225, v29, v21
  v_fma_f32 v30, -v226, v30, v22
  v_fma_f32 v31, -v227, v31, v23
  v_fma_f32 v16, v24, v212, v220
  v_fma_f32 v17, v25, v213, v221
  v_fma_f32 v18, v26, v214, v222
  v_fma_f32 v19, v27, v215, v223
  v_fma_f32 v20, v28, v216, v224
  v_fma_f32 v21, v29, v217, v225
  v_fma_f32 v22, v30, v218, v226
  v_fma_f32 v23, v31, v219, v227
  v_cvt_pk_bf16_f32 v192, v16, v17
  v_cvt_pk_bf16_f32 v193, v18, v19
  v_cvt_pk_bf16_f32 v194, v20, v21
  v_cvt_pk_bf16_f32 v195, v22, v23
  s_nop 0
  v_mov_b32 v196, v192 row_ror:8 row_mask:0xf bank_mask:0xf
  v_mov_b32 v197, v193 row_ror:8 row_mask:0xf bank_mask:0xf
  v_mov_b32 v198, v194 row_ror:8 row_mask:0xf bank_mask:0xf
  v_mov_b32 v199, v195 row_ror:8 row_mask:0xf bank_mask:0xf
  v_lshlrev_b32 v16, 16, v200
  v_and_b32 v17, 0xffff0000, v200
  v_lshlrev_b32 v18, 16, v201
  v_and_b32 v19, 0xffff0000, v201
  v_lshlrev_b32 v20, 16, v202
  v_and_b32 v21, 0xffff0000, v202
  v_lshlrev_b32 v22, 16, v203
  v_and_b32 v23, 0xffff0000, v203
  v_max_f32 v16, 0xc2ae0000, v16
  v_max_f32 v17, 0xc2ae0000, v17
  v_max_f32 v18, 0xc2ae0000, v18
  v_max_f32 v19, 0xc2ae0000, v19
  v_max_f32 v20, 0xc2ae0000, v20
  v_max_f32 v21, 0xc2ae0000, v21
  v_max_f32 v22, 0xc2ae0000, v22
  v_max_f32 v23, 0xc2ae0000, v23
  v_mul_f32 v24, 0xbfb8aa3b, v16
  v_mul_f32 v25, 0xbfb8aa3b, v17
  v_mul_f32 v26, 0xbfb8aa3b, v18
  v_mul_f32 v27, 0xbfb8aa3b, v19
  v_mul_f32 v28, 0xbfb8aa3b, v20
  v_mul_f32 v29, 0xbfb8aa3b, v21
  v_mul_f32 v30, 0xbfb8aa3b, v22
  v_mul_f32 v31, 0xbfb8aa3b, v23
  v_exp_f32 v24, v24
  v_exp_f32 v25, v25
  v_exp_f32 v26, v26
  v_exp_f32 v27, v27
  v_exp_f32 v28, v28
  v_exp_f32 v29, v29
  v_exp_f32 v30, v30
  v_exp_f32 v31, v31
  v_add_f32 v24, 1.0, v24
  v_add_f32 v25, 1.0, v25
  v_add_f32 v26, 1.0, v26
  v_add_f32 v27, 1.0, v27
  v_add_f32 v28, 1.0, v28
  v_add_f32 v29, 1.0, v29
  v_add_f32 v30, 1.0, v30
  v_add_f32 v31, 1.0, v31
  v_rcp_f32 v212, v24
  v_rcp_f32 v213, v25
  v_rcp_f32 v214, v26
  v_rcp_f32 v215, v27
  v_rcp_f32 v216, v28
  v_rcp_f32 v217, v29
  v_rcp_f32 v218, v30
  v_rcp_f32 v219, v31
  v_mul_f32 v220, v16, v212
  v_mul_f32 v221, v17, v213
  v_mul_f32 v222, v18, v214
  v_mul_f32 v223, v19, v215
  v_mul_f32 v224, v20, v216
  v_mul_f32 v225, v21, v217
  v_mul_f32 v226, v22, v218
  v_mul_f32 v227, v23, v219
  v_fma_f32 v24, -v220, v24, v16
  v_fma_f32 v25, -v221, v25, v17
  v_fma_f32 v26, -v222, v26, v18
  v_fma_f32 v27, -v223, v27, v19
  v_fma_f32 v28, -v224, v28, v20
  v_fma_f32 v29, -v225, v29, v21
  v_fma_f32 v30, -v226, v30, v22
  v_fma_f32 v31, -v227, v31, v23
  v_fma_f32 v16, v24, v212, v220
  v_fma_f32 v17, v25, v213, v221
  v_fma_f32 v18, v26, v214, v222
  v_fma_f32 v19, v27, v215, v223
  v_fma_f32 v20, v28, v216, v224
  v_fma_f32 v21, v29, v217, v225
  v_fma_f32 v22, v30, v218, v226
  v_fma_f32 v23, v31, v219, v227
  v_cvt_pk_bf16_f32 v200, v16, v17
  v_cvt_pk_bf16_f32 v201, v18, v19
  v_cvt_pk_bf16_f32 v202, v20, v21
  v_cvt_pk_bf16_f32 v203, v22, v23
  s_nop 0
  v_mov_b32 v204, v200 row_ror:8 row_mask:0xf bank_mask:0xf
  v_mov_b32 v205, v201 row_ror:8 row_mask:0xf bank_mask:0xf
  v_mov_b32 v206, v202 row_ror:8 row_mask:0xf bank_mask:0xf
  v_mov_b32 v207, v203 row_ror:8 row_mask:0xf bank_mask:0xf
  v_lshlrev_b32 v16, 16, v208
  v_and_b32 v17, 0xffff0000, v208
  v_lshlrev_b32 v18, 16, v209
  v_and_b32 v19, 0xffff0000, v209
  v_lshlrev_b32 v20, 16, v210
  v_and_b32 v21, 0xffff0000, v210
  v_lshlrev_b32 v22, 16, v211
  v_and_b32 v23, 0xffff0000, v211
  v_max_f32 v16, 0xc2ae0000, v16
  v_max_f32 v17, 0xc2ae0000, v17
  v_max_f32 v18, 0xc2ae0000, v18
  v_max_f32 v19, 0xc2ae0000, v19
  v_max_f32 v20, 0xc2ae0000, v20
  v_max_f32 v21, 0xc2ae0000, v21
  v_max_f32 v22, 0xc2ae0000, v22
  v_max_f32 v23, 0xc2ae0000, v23
  v_mul_f32 v24, 0xbfb8aa3b, v16
  v_mul_f32 v25, 0xbfb8aa3b, v17
  v_mul_f32 v26, 0xbfb8aa3b, v18
  v_mul_f32 v27, 0xbfb8aa3b, v19
  v_mul_f32 v28, 0xbfb8aa3b, v20
  v_mul_f32 v29, 0xbfb8aa3b, v21
  v_mul_f32 v30, 0xbfb8aa3b, v22
  v_mul_f32 v31, 0xbfb8aa3b, v23
  v_exp_f32 v24, v24
  v_exp_f32 v25, v25
  v_exp_f32 v26, v26
  v_exp_f32 v27, v27
  v_exp_f32 v28, v28
  v_exp_f32 v29, v29
  v_exp_f32 v30, v30
  v_exp_f32 v31, v31
  v_add_f32 v24, 1.0, v24
  v_add_f32 v25, 1.0, v25
  v_add_f32 v26, 1.0, v26
  v_add_f32 v27, 1.0, v27
  v_add_f32 v28, 1.0, v28
  v_add_f32 v29, 1.0, v29
  v_add_f32 v30, 1.0, v30
  v_add_f32 v31, 1.0, v31
  v_rcp_f32 v212, v24
  v_rcp_f32 v213, v25
  v_rcp_f32 v214, v26
  v_rcp_f32 v215, v27
  v_rcp_f32 v216, v28
  v_rcp_f32 v217, v29
  v_rcp_f32 v218, v30
  v_rcp_f32 v219, v31
  v_mul_f32 v220, v16, v212
  v_mul_f32 v221, v17, v213
  v_mul_f32 v222, v18, v214
  v_mul_f32 v223, v19, v215
  v_mul_f32 v224, v20, v216
  v_mul_f32 v225, v21, v217
  v_mul_f32 v226, v22, v218
  v_mul_f32 v227, v23, v219
  v_fma_f32 v24, -v220, v24, v16
  v_fma_f32 v25, -v221, v25, v17
  v_fma_f32 v26, -v222, v26, v18
  v_fma_f32 v27, -v223, v27, v19
  v_fma_f32 v28, -v224, v28, v20
  v_fma_f32 v29, -v225, v29, v21
  v_fma_f32 v30, -v226, v30, v22
  v_fma_f32 v31, -v227, v31, v23
  v_fma_f32 v16, v24, v212, v220
  v_fma_f32 v17, v25, v213, v221
  v_fma_f32 v18, v26, v214, v222
  v_fma_f32 v19, v27, v215, v223
  v_fma_f32 v20, v28, v216, v224
  v_fma_f32 v21, v29, v217, v225
  v_fma_f32 v22, v30, v218, v226
  v_fma_f32 v23, v31, v219, v227
  v_cvt_pk_bf16_f32 v208, v16, v17
  v_cvt_pk_bf16_f32 v209, v18, v19
  v_cvt_pk_bf16_f32 v210, v20, v21
  v_cvt_pk_bf16_f32 v211, v22, v23
  v_mov_b32 v10, 147456
  s_mov_b32 s58, 12578616
sp_37:
  ds_read_b32 v11, v10
  s_waitcnt lgkmcnt(0)
  v_readfirstlane_b32 s8, v11
  s_cmp_ge_u32 s8, 14
  s_cbranch_scc1 sp_37_ok
  s_sleep 16
  s_sub_u32 s58, s58, 1
  s_cbranch_scc0 sp_37
sp_37_ok:
  s_mov_b32 s44, s36
  s_mov_b32 s45, s37
  s_mov_b32 s46, 3981312
  s_mov_b32 s47, 0x20000
  s_mul_i32 s8, s63, 288
  s_mul_i32 s8, s8, s7
  s_add_u32 s6, s6, s8
  s_lshl_b32 s8, s7, 3
  v_mul_lo_u32 v3, v1, s8
  v_lshl_add_u32 v3, v2, 3, v3
  buffer_load_dwordx2 v[32:33], v3, s[44:47], s6 offen nt
  s_add_u32 s6, s6, s7
  buffer_load_dwordx2 v[34:35], v3, s[44:47], s6 offen nt
  s_add_u32 s6, s6, s7
  buffer_load_dwordx2 v[36:37], v3, s[44:47], s6 offen nt
  s_add_u32 s6, s6, s7
  buffer_load_dwordx2 v[38:39], v3, s[44:47], s6 offen nt
  s_add_u32 s6, s6, s7
  buffer_load_dwordx2 v[40:41], v3, s[44:47], s6 offen nt
  s_add_u32 s6, s6, s7
  buffer_load_dwordx2 v[42:43], v3, s[44:47], s6 offen nt
  s_add_u32 s6, s6, s7
  buffer_load_dwordx2 v[44:45], v3, s[44:47], s6 offen nt
  s_add_u32 s6, s6, s7
  buffer_load_dwordx2 v[46:47], v3, s[44:47], s6 offen nt
  s_waitcnt vmcnt(7)
  s_mul_i32 s8, s7, 25
  s_add_i32 s6, s6, s8
  buffer_load_dwordx2 v[48:49], v3, s[44:47], s6 offen nt
  s_waitcnt vmcnt(7)
  s_add_u32 s6, s6, s7
  buffer_load_dwordx2 v[50:51], v3, s[44:47], s6 offen nt
  s_waitcnt vmcnt(7)
  s_add_u32 s6, s6, s7
  buffer_load_dwordx2 v[52:53], v3, s[44:47], s6 offen nt
  s_waitcnt vmcnt(7)
  s_add_u32 s6, s6, s7
  buffer_load_dwordx2 v[54:55], v3, s[44:47], s6 offen nt
  s_waitcnt vmcnt(7)
  s_add_u32 s6, s6, s7
  buffer_load_dwordx2 v[56:57], v3, s[44:47], s6 offen nt
  s_waitcnt vmcnt(7)
  s_add_u32 s6, s6, s7
  buffer_load_dwordx2 v[58:59], v3, s[44:47], s6 offen nt
  s_waitcnt vmcnt(7)
  s_add_u32 s6, s6, s7
  buffer_load_dwordx2 v[60:61], v3, s[44:47], s6 offen nt
  s_waitcnt vmcnt(7)
  s_add_u32 s6, s6, s7
  buffer_load_dwordx2 v[62:63], v3, s[44:47], s6 offen nt
  s_waitcnt vmcnt(7)
  s_mul_i32 s8, s7, 25
  s_add_i32 s6, s6, s8
  buffer_load_dwordx2 v[64:65], v3, s[44:47], s6 offen nt
  s_waitcnt vmcnt(7)
  s_add_u32 s6, s6, s7
  buffer_load_dwordx2 v[66:67], v3, s[44:47], s6 offen nt
  s_waitcnt vmcnt(7)
  s_add_u32 s6, s6, s7
  buffer_load_dwordx2 v[68:69], v3, s[44:47], s6 offen nt
  s_waitcnt vmcnt(7)
  s_add_u32 s6, s6, s7
  buffer_load_dwordx2 v[70:71], v3, s[44:47], s6 offen nt
  s_waitcnt vmcnt(7)
  s_add_u32 s6, s6, s7
  buffer_load_dwordx2 v[72:73], v3, s[44:47], s6 offen nt
  s_waitcnt vmcnt(7)
  s_add_u32 s6, s6, s7
  buffer_load_dwordx2 v[74:75], v3, s[44:47], s6 offen nt
  s_waitcnt vmcnt(7)
  s_add_u32 s6, s6, s7
  buffer_load_dwordx2 v[76:77], v3, s[44:47], s6 offen nt
  s_waitcnt vmcnt(7)
  s_add_u32 s6, s6, s7
  buffer_load_dwordx2 v[78:79], v3, s[44:47], s6 offen nt
  s_waitcnt vmcnt(7)
  s_mul_i32 s8, s7, 25
  s_add_i32 s6, s6, s8
  buffer_load_dwordx2 v[80:81], v3, s[44:47], s6 offen nt
  s_waitcnt vmcnt(7)
  s_add_u32 s6, s6, s7
  buffer_load_dwordx2 v[82:83], v3, s[44:47], s6 offen nt
  s_waitcnt vmcnt(7)
  s_add_u32 s6, s6, s7
  buffer_load_dwordx2 v[84:85], v3, s[44:47], s6 offen nt
  s_waitcnt vmcnt(7)
  s_add_u32 s6, s6, s7
  buffer_load_dwordx2 v[86:87], v3, s[44:47], s6 offen nt
  s_waitcnt vmcnt(7)
  s_add_u32 s6, s6, s7
  buffer_load_dwordx2 v[88:89], v3, s[44:47], s6 offen nt
  s_waitcnt vmcnt(7)
  s_add_u32 s6, s6, s7
  buffer_load_dwordx2 v[90:91], v3, s[44:47], s6 offen nt
  s_waitcnt vmcnt(7)
  s_add_u32 s6, s6, s7
  buffer_load_dwordx2 v[92:93], v3, s[44:47], s6 offen nt
  s_waitcnt vmcnt(7)
  s_add_u32 s6, s6, s7
  buffer_load_dwordx2 v[94:95], v3, s[44:47], s6 offen nt
  s_waitcnt vmcnt(7)
  s_mul_i32 s8, s7, 25
  s_add_i32 s6, s6, s8
  buffer_load_dwordx2 v[96:97], v3, s[44:47], s6 offen nt
  s_waitcnt vmcnt(7)
  s_add_u32 s6, s6, s7
  buffer_load_dwordx2 v[98:99], v3, s[44:47], s6 offen nt
  s_waitcnt vmcnt(7)
  s_add_u32 s6, s6, s7
  buffer_load_dwordx2 v[100:101], v3, s[44:47], s6 offen nt
  s_waitcnt vmcnt(7)
  s_add_u32 s6, s6, s7
  buffer_load_dwordx2 v[102:103], v3, s[44:47], s6 offen nt
  s_waitcnt vmcnt(7)
  s_add_u32 s6, s6, s7
  buffer_load_dwordx2 v[104:105], v3, s[44:47], s6 offen nt
  s_waitcnt vmcnt(7)
  s_add_u32 s6, s6, s7
  buffer_load_dwordx2 v[106:107], v3, s[44:47], s6 offen nt
  s_waitcnt vmcnt(7)
  s_add_u32 s6, s6, s7
  buffer_load_dwordx2 v[108:109], v3, s[44:47], s6 offen nt
  s_waitcnt vmcnt(7)
  s_add_u32 s6, s6, s7
  buffer_load_dwordx2 v[110:111], v3, s[44:47], s6 offen nt
  s_waitcnt vmcnt(7)
  s_mul_i32 s8, s7, 25
  s_add_i32 s6, s6, s8
  buffer_load_dwordx2 v[112:113], v3, s[44:47], s6 offen nt
  s_waitcnt vmcnt(7)
  s_add_u32 s6, s6, s7
  buffer_load_dwordx2 v[114:115], v3, s[44:47], s6 offen nt
  s_waitcnt vmcnt(7)
  s_add_u32 s6, s6, s7
  buffer_load_dwordx2 v[116:117], v3, s[44:47], s6 offen nt
  s_waitcnt vmcnt(7)
  s_add_u32 s6, s6, s7
  buffer_load_dwordx2 v[118:119], v3, s[44:47], s6 offen nt
  s_waitcnt vmcnt(7)
  s_add_u32 s6, s6, s7
  buffer_load_dwordx2 v[120:121], v3, s[44:47], s6 offen nt
  s_waitcnt vmcnt(7)
  s_add_u32 s6, s6, s7
  buffer_load_dwordx2 v[122:123], v3, s[44:47], s6 offen nt
  s_waitcnt vmcnt(7)
  s_add_u32 s6, s6, s7
  buffer_load_dwordx2 v[124:125], v3, s[44:47], s6 offen nt
  s_waitcnt vmcnt(7)
  s_add_u32 s6, s6, s7
  buffer_load_dwordx2 v[126:127], v3, s[44:47], s6 offen nt
  s_waitcnt vmcnt(7)
  s_mul_i32 s8, s7, 25
  s_add_i32 s6, s6, s8
  buffer_load_dwordx2 v[128:129], v3, s[44:47], s6 offen nt
  s_waitcnt vmcnt(7)
  s_add_u32 s6, s6, s7
  buffer_load_dwordx2 v[130:131], v3, s[44:47], s6 offen nt
  s_waitcnt vmcnt(7)
  s_add_u32 s6, s6, s7
  buffer_load_dwordx2 v[132:133], v3, s[44:47], s6 offen nt
  s_waitcnt vmcnt(7)
  s_add_u32 s6, s6, s7
  buffer_load_dwordx2 v[134:135], v3, s[44:47], s6 offen nt
  s_waitcnt vmcnt(7)
  s_add_u32 s6, s6, s7
  buffer_load_dwordx2 v[136:137], v3, s[44:47], s6 offen nt
  s_waitcnt vmcnt(7)
  s_add_u32 s6, s6, s7
  buffer_load_dwordx2 v[138:139], v3, s[44:47], s6 offen nt
  s_waitcnt vmcnt(7)
  s_add_u32 s6, s6, s7
  buffer_load_dwordx2 v[140:141], v3, s[44:47], s6 offen nt
  s_waitcnt vmcnt(7)
  s_add_u32 s6, s6, s7
  buffer_load_dwordx2 v[142:143], v3, s[44:47], s6 offen nt
  s_waitcnt vmcnt(7)
  s_mul_i32 s8, s7, 25
  s_add_i32 s6, s6, s8
  buffer_load_dwordx2 v[144:145], v3, s[44:47], s6 offen nt
  s_waitcnt vmcnt(7)
  s_add_u32 s6, s6, s7
  buffer_load_dwordx2 v[146:147], v3, s[44:47], s6 offen nt
  s_waitcnt vmcnt(7)
  s_add_u32 s6, s6, s7
  buffer_load_dwordx2 v[148:149], v3, s[44:47], s6 offen nt
  s_waitcnt vmcnt(7)
  s_add_u32 s6, s6, s7
  buffer_load_dwordx2 v[150:151], v3, s[44:47], s6 offen nt
  s_waitcnt vmcnt(7)
  s_add_u32 s6, s6, s7
  buffer_load_dwordx2 v[152:153], v3, s[44:47], s6 offen nt
  s_waitcnt vmcnt(7)
  s_add_u32 s6, s6, s7
  buffer_load_dwordx2 v[154:155], v3, s[44:47], s6 offen nt
  s_waitcnt vmcnt(7)
  s_add_u32 s6, s6, s7
  buffer_load_dwordx2 v[156:157], v3, s[44:47], s6 offen nt
  s_waitcnt vmcnt(7)
  s_add_u32 s6, s6, s7
  buffer_load_dwordx2 v[158:159], v3, s[44:47], s6 offen nt
  s_waitcnt vmcnt(7)
  s_mul_i32 s8, s7, 25
  s_add_i32 s6, s6, s8
  buffer_load_dwordx2 v[160:161], v3, s[44:47], s6 offen nt
  s_waitcnt vmcnt(7)
  s_add_u32 s6, s6, s7
  buffer_load_dwordx2 v[162:163], v3, s[44:47], s6 offen nt
  s_waitcnt vmcnt(7)
  s_add_u32 s6, s6, s7
  buffer_load_dwordx2 v[164:165], v3, s[44:47], s6 offen nt
  s_waitcnt vmcnt(7)
  s_add_u32 s6, s6, s7
  buffer_load_dwordx2 v[166:167], v3, s[44:47], s6 offen nt
  s_waitcnt vmcnt(7)
  s_add_u32 s6, s6, s7
  buffer_load_dwordx2 v[168:169], v3, s[44:47], s6 offen nt
  s_waitcnt vmcnt(7)
  s_add_u32 s6, s6, s7
  buffer_load_dwordx2 v[170:171], v3, s[44:47], s6 offen nt
  s_waitcnt vmcnt(7)
  s_add_u32 s6, s6, s7
  buffer_load_dwordx2 v[172:173], v3, s[44:47], s6 offen nt
  s_waitcnt vmcnt(7)
  s_add_u32 s6, s6, s7
  buffer_load_dwordx2 v[174:175], v3, s[44:47], s6 offen nt
  s_waitcnt vmcnt(63)
  v_perm_b32 v16, v34, v32, s60
  v_perm_b32 v17, v38, v36, s60
  v_perm_b32 v18, v42, v40, s60
  v_perm_b32 v19, v46, v44, s60
  v_perm_b32 v20, v34, v32, s61
  v_perm_b32 v21, v38, v36, s61
  v_perm_b32 v22, v42, v40, s61
  v_perm_b32 v23, v46, v44, s61
  v_perm_b32 v24, v35, v33, s60
  v_perm_b32 v25, v39, v37, s60
  v_perm_b32 v26, v43, v41, s60
  v_perm_b32 v27, v47, v45, s60
  v_perm_b32 v28, v35, v33, s61
  v_perm_b32 v29, v39, v37, s61
  v_perm_b32 v30, v43, v41, s61
  v_perm_b32 v31, v47, v45, s61
  s_waitcnt vmcnt(56)
  v_perm_b32 v32, v50, v48, s60
  v_perm_b32 v33, v54, v52, s60
  v_perm_b32 v34, v58, v56, s60
  v_perm_b32 v35, v62, v60, s60
  v_perm_b32 v36, v50, v48, s61
  v_perm_b32 v37, v54, v52, s61
  v_perm_b32 v38, v58, v56, s61
  v_perm_b32 v39, v62, v60, s61
  v_perm_b32 v40, v51, v49, s60
  v_perm_b32 v41, v55, v53, s60
  v_perm_b32 v42, v59, v57, s60
  v_perm_b32 v43, v63, v61, s60
  v_perm_b32 v44, v51, v49, s61
  v_perm_b32 v45, v55, v53, s61
  v_perm_b32 v46, v59, v57, s61
  v_perm_b32 v47, v63, v61, s61
  s_waitcnt vmcnt(48)
  v_perm_b32 v48, v66, v64, s60
  v_perm_b32 v49, v70, v68, s60
  v_perm_b32 v50, v74, v72, s60
  v_perm_b32 v51, v78, v76, s60
  v_perm_b32 v52, v66, v64, s61
  v_perm_b32 v53, v70, v68, s61
  v_perm_b32 v54, v74, v72, s61
  v_perm_b32 v55, v78, v76, s61
  v_perm_b32 v56, v67, v65, s60
  v_perm_b32 v57, v71, v69, s60
  v_perm_b32 v58, v75, v73, s60
  v_perm_b32 v59, v79, v77, s60
  v_perm_b32 v60, v67, v65, s61
  v_perm_b32 v61, v71, v69, s61
  v_perm_b32 v62, v75, v73, s61
  v_perm_b32 v63, v79, v77, s61
  s_waitcnt vmcnt(40)
  v_perm_b32 v64, v82, v80, s60
  v_perm_b32 v65, v86, v84, s60
  v_perm_b32 v66, v90, v88, s60
  v_perm_b32 v67, v94, v92, s60
  v_perm_b32 v68, v82, v80, s61
  v_perm_b32 v69, v86, v84, s61
  v_perm_b32 v70, v90, v88, s61
  v_perm_b32 v71, v94, v92, s61
  v_perm_b32 v72, v83, v81, s60
  v_perm_b32 v73, v87, v85, s60
  v_perm_b32 v74, v91, v89, s60
  v_perm_b32 v75, v95, v93, s60
  v_perm_b32 v76, v83, v81, s61
  v_perm_b32 v77, v87, v85, s61
  v_perm_b32 v78, v91, v89, s61
  v_perm_b32 v79, v95, v93, s61
  s_waitcnt vmcnt(32)
  v_perm_b32 v80, v98, v96, s60
  v_perm_b32 v81, v102, v100, s60
  v_perm_b32 v82, v106, v104, s60
  v_perm_b32 v83, v110, v108, s60
  v_perm_b32 v84, v98, v96, s61
  v_perm_b32 v85, v102, v100, s61
  v_perm_b32 v86, v106, v104, s61
  v_perm_b32 v87, v110, v108, s61
  v_perm_b32 v88, v99, v97, s60
  v_perm_b32 v89, v103, v101, s60
  v_perm_b32 v90, v107, v105, s60
  v_perm_b32 v91, v111, v109, s60
  v_perm_b32 v92, v99, v97, s61
  v_perm_b32 v93, v103, v101, s61
  v_perm_b32 v94, v107, v105, s61
  v_perm_b32 v95, v111, v109, s61
  s_waitcnt vmcnt(24)
  v_perm_b32 v96, v114, v112, s60
  v_perm_b32 v97, v118, v116, s60
  v_perm_b32 v98, v122, v120, s60
  v_perm_b32 v99, v126, v124, s60
  v_perm_b32 v100, v114, v112, s61
  v_perm_b32 v101, v118, v116, s61
  v_perm_b32 v102, v122, v120, s61
  v_perm_b32 v103, v126, v124, s61
  v_perm_b32 v104, v115, v113, s60
  v_perm_b32 v105, v119, v117, s60
  v_perm_b32 v106, v123, v121, s60
  v_perm_b32 v107, v127, v125, s60
  v_perm_b32 v108, v115, v113, s61
  v_perm_b32 v109, v119, v117, s61
  v_perm_b32 v110, v123, v121, s61
  v_perm_b32 v111, v127, v125, s61
  s_waitcnt vmcnt(16)
  v_perm_b32 v112, v130, v128, s60
  v_perm_b32 v113, v134, v132, s60
  v_perm_b32 v114, v138, v136, s60
  v_perm_b32 v115, v142, v140, s60
  v_perm_b32 v116, v130, v128, s61
  v_perm_b32 v117, v134, v132, s61
  v_perm_b32 v118, v138, v136, s61
  v_perm_b32 v119, v142, v140, s61
  v_perm_b32 v120, v131, v129, s60
  v_perm_b32 v121, v135, v133, s60
  v_perm_b32 v122, v139, v137, s60
  v_perm_b32 v123, v143, v141, s60
  v_perm_b32 v124, v131, v129, s61
  v_perm_b32 v125, v135, v133, s61
  v_perm_b32 v126, v139, v137, s61
  v_perm_b32 v127, v143, v141, s61
  s_waitcnt vmcnt(8)
  v_perm_b32 v128, v146, v144, s60
  v_perm_b32 v129, v150, v148, s60
  v_perm_b32 v130, v154, v152, s60
  v_perm_b32 v131, v158, v156, s60
  v_perm_b32 v132, v146, v144, s61
  v_perm_b32 v133, v150, v148, s61
  v_perm_b32 v134, v154, v152, s61
  v_perm_b32 v135, v158, v156, s61
  v_perm_b32 v136, v147, v145, s60
  v_perm_b32 v137, v151, v149, s60
  v_perm_b32 v138, v155, v153, s60
  v_perm_b32 v139, v159, v157, s60
  v_perm_b32 v140, v147, v145, s61
  v_perm_b32 v141, v151, v149, s61
  v_perm_b32 v142, v155, v153, s61
  v_perm_b32 v143, v159, v157, s61
  s_waitcnt vmcnt(0)
  v_perm_b32 v144, v162, v160, s60
  v_perm_b32 v145, v166, v164, s60
  v_perm_b32 v146, v170, v168, s60
  v_perm_b32 v147, v174, v172, s60
  v_perm_b32 v148, v162, v160, s61
  v_perm_b32 v149, v166, v164, s61
  v_perm_b32 v150, v170, v168, s61
  v_perm_b32 v151, v174, v172, s61
  v_perm_b32 v152, v163, v161, s60
  v_perm_b32 v153, v167, v165, s60
  v_perm_b32 v154, v171, v169, s60
  v_perm_b32 v155, v175, v173, s60
  v_perm_b32 v156, v163, v161, s61
  v_perm_b32 v157, v167, v165, s61
  v_perm_b32 v158, v171, v169, s61
  v_perm_b32 v159, v175, v173, s61
  s_nop 1
  v_mfma_f32_16x16x32_bf16 v[212:215], v[16:19], v[176:179], 0
  v_mfma_f32_16x16x32_bf16 v[216:219], v[20:23], v[176:179], 0
  v_mfma_f32_16x16x32_bf16 v[220:223], v[24:27], v[176:179], 0
  v_mfma_f32_16x16x32_bf16 v[224:227], v[28:31], v[176:179], 0
  v_mfma_f32_16x16x32_bf16 v[212:215], v[32:35], v[180:183], v[212:215]
  v_mfma_f32_16x16x32_bf16 v[216:219], v[36:39], v[180:183], v[216:219]
  v_mfma_f32_16x16x32_bf16 v[220:223], v[40:43], v[180:183], v[220:223]
  v_mfma_f32_16x16x32_bf16 v[224:227], v[44:47], v[180:183], v[224:227]
  v_mfma_f32_16x16x32_bf16 v[212:215], v[48:51], v[184:187], v[212:215]
  v_mfma_f32_16x16x32_bf16 v[216:219], v[52:55], v[184:187], v[216:219]
  v_mfma_f32_16x16x32_bf16 v[220:223], v[56:59], v[184:187], v[220:223]
  v_mfma_f32_16x16x32_bf16 v[224:227], v[60:63], v[184:187], v[224:227]
  v_mfma_f32_16x16x32_bf16 v[212:215], v[64:67], v[188:191], v[212:215]
  v_mfma_f32_16x16x32_bf16 v[216:219], v[68:71], v[188:191], v[216:219]
  v_mfma_f32_16x16x32_bf16 v[220:223], v[72:75], v[188:191], v[220:223]
  v_mfma_f32_16x16x32_bf16 v[224:227], v[76:79], v[188:191], v[224:227]
  v_mfma_f32_16x16x32_bf16 v[212:215], v[80:83], v[192:195], v[212:215]
  v_mfma_f32_16x16x32_bf16 v[216:219], v[84:87], v[192:195], v[216:219]
  v_mfma_f32_16x16x32_bf16 v[220:223], v[88:91], v[192:195], v[220:223]
  v_mfma_f32_16x16x32_bf16 v[224:227], v[92:95], v[192:195], v[224:227]
  v_mfma_f32_16x16x32_bf16 v[212:215], v[96:99], v[196:199], v[212:215]
  v_mfma_f32_16x16x32_bf16 v[216:219], v[100:103], v[196:199], v[216:219]
  v_mfma_f32_16x16x32_bf16 v[220:223], v[104:107], v[196:199], v[220:223]
  v_mfma_f32_16x16x32_bf16 v[224:227], v[108:111], v[196:199], v[224:227]
  v_mfma_f32_16x16x32_bf16 v[212:215], v[112:115], v[200:203], v[212:215]
  v_mfma_f32_16x16x32_bf16 v[216:219], v[116:119], v[200:203], v[216:219]
  v_mfma_f32_16x16x32_bf16 v[220:223], v[120:123], v[200:203], v[220:223]
  v_mfma_f32_16x16x32_bf16 v[224:227], v[124:127], v[200:203], v[224:227]
  v_mfma_f32_16x16x32_bf16 v[212:215], v[128:131], v[204:207], v[212:215]
  v_mfma_f32_16x16x32_bf16 v[216:219], v[132:135], v[204:207], v[216:219]
  v_mfma_f32_16x16x32_bf16 v[220:223], v[136:139], v[204:207], v[220:223]
  v_mfma_f32_16x16x32_bf16 v[224:227], v[140:143], v[204:207], v[224:227]
  v_mfma_f32_16x16x32_bf16 v[212:215], v[144:147], v[208:211], v[212:215]
  v_mfma_f32_16x16x32_bf16 v[216:219], v[148:151], v[208:211], v[216:219]
  v_mfma_f32_16x16x32_bf16 v[220:223], v[152:155], v[208:211], v[220:223]
  v_mfma_f32_16x16x32_bf16 v[224:227], v[156:159], v[208:211], v[224:227]
  s_nop 4
  s_mov_b32 s10, 0x00ff00ff
  s_mov_b32 s11, 0x00ff00ff
  s_mov_b64 exec, s[10:11]
  ds_write_b128 v13, v[212:215] offset:0
  ds_write_b128 v13, v[216:219] offset:16
  ds_write_b128 v13, v[220:223] offset:32
  ds_write_b128 v13, v[224:227] offset:48
  s_mov_b64 exec, -1
  s_waitcnt lgkmcnt(0)
  v_and_b32 v5, 7, v0
  v_lshlrev_b32 v5, 2, v5
  s_mov_b32 s10, 31
  s_mov_b32 s11, 0
fl_38:
  buffer_load_dword v6, v5, s[52:55], 0 offen sc1
  s_waitcnt vmcnt(0)
  v_cmp_eq_u32 vcc, 0, v6
  s_and_b64 vcc, vcc, s[10:11]
  s_cbranch_scc0 fle_39
  s_sleep 8
  s_sub_u32 s15, s15, 1
  s_cbranch_scc0 fl_38
  s_mov_b32 s15, 0
fle_39:
  v_mov_b32 v10, 147488
  v_mov_b32 v11, 1
  s_mov_b64 exec, 1
  ds_add_u32 v10, v11
  s_mov_b64 exec, -1
  s_mov_b32 s58, 133333333
sp_40:
  ds_read_b32 v11, v10
  s_waitcnt lgkmcnt(0)
  v_readfirstlane_b32 s8, v11
  s_cmp_ge_u32 s8, 4
  s_cbranch_scc1 sp_40_ok
  s_sub_u32 s58, s58, 1
  s_cbranch_scc0 sp_40
sp_40_ok:
  ds_read_b32 v212, v14 offset:0
  ds_read_b32 v213, v14 offset:16
  ds_read_b32 v214, v14 offset:2176
  ds_read_b32 v215, v14 offset:2192
  ds_read_b32 v216, v14 offset:4352
  ds_read_b32 v217, v14 offset:4368
  ds_read_b32 v218, v14 offset:6528
  ds_read_b32 v219, v14 offset:6544
  s_waitcnt lgkmcnt(4)
  v_add_f32 v212, v212, v214
  v_add_f32 v213, v213, v215
  s_waitcnt lgkmcnt(0)
  v_add_f32 v216, v216, v218
  v_add_f32 v217, v217, v219
  v_lshrrev_b32 v7, 5, v0
  v_lshlrev_b32 v7, 4, v7
  v_and_b32 v6, 3, v0
  v_lshl_add_u32 v7, v6, 2, v7
  v_bfe_u32 v6, v0, 2, 3
  v_mul_u32_u24 v6, 1152, v6
  v_add_u32 v7, v7, v6
  s_lshl_b32 s59, s56, 7
  s_lshl_b32 s8, s9, 5
  s_add_u32 s59, s59, s8
  s_cmp_eq_u32 s57, 1
  s_cselect_b32 s6, 9216, 0
  s_movk_i32 s7, 27648
  s_cselect_b32 s7, 9216, s7
  s_add_u32 s6, s6, s59
  s_add_u32 s6, s6, 86016
  s_add_u32 s7, s7, s6
  v_cvt_pk_bf16_f32 v10, v212, v213
  v_cvt_pk_bf16_f32 v11, v216, v217
  buffer_store_dword v10, v7, s[48:51], s6 offen sc1
  buffer_store_dword v11, v7, s[48:51], s7 offen sc1
  s_branch L_mid2
L_midF:
  s_cmp_ge_u32 s9, 2
  s_cbranch_scc0 L_mF0
  v_mov_b32 v16, 0
  v_mov_b32 v17, 0
  v_mov_b32 v18, 0
  v_mov_b32 v19, 0
  v_mov_b32 v20, 0
  v_mov_b32 v21, 0
  v_mov_b32 v22, 0
  v_mov_b32 v23, 0
  v_mov_b32 v24, 0
  v_mov_b32 v25, 0
  v_mov_b32 v26, 0
  v_mov_b32 v27, 0
  v_mov_b32 v28, 0
  v_mov_b32 v29, 0
  v_mov_b32 v30, 0
  v_mov_b32 v31, 0
  v_mov_b32 v32, 0
  v_mov_b32 v33, 0
  v_mov_b32 v34, 0
  v_mov_b32 v35, 0
  v_mov_b32 v36, 0
  v_mov_b32 v37, 0
  v_mov_b32 v38, 0
  v_mov_b32 v39, 0
  v_mov_b32 v40, 0
  v_mov_b32 v41, 0
  v_mov_b32 v42, 0
  v_mov_b32 v43, 0
  v_mov_b32 v44, 0
  v_mov_b32 v45, 0
  v_mov_b32 v46, 0
  v_mov_b32 v47, 0
  s_branch L_mF1
L_mF0:
  s_lshl_b32 s8, s9, 2
  s_min_u32 s6, s9, 1
  s_add_u32 s8, s8, s6
  s_add_u32 s8, s8, 0
  s_mul_i32 s6, s8, 294912
  s_mul_i32 s7, s4, 1152
  s_add_u32 s6, s6, s7
  s_lshl_b32 s7, s5, 7
  s_add_u32 s6, s6, s7
  v_and_b32 v5, 7, v0
  v_mul_u32_u24 v3, 73728, v1
  v_lshl_add_u32 v3, v5, 4, v3
  v_add_u32 v3, s6, v3
  v_and_b32 v5, 8, v0
  v_cmp_eq_u32 vcc, 0, v5
  v_mov_b32 v4, s30
  v_mov_b32 v5, s31
  v_mov_b32 v6, s28
  v_mov_b32 v7, s29
  v_cndmask_b32 v4, v4, v6, vcc
  v_cndmask_b32 v5, v5, v7, vcc
  v_add_co_u32 v4, vcc, v4, v3
  s_mov_b32 s44, 9216
  s_mov_b32 s45, 0
  v_addc_co_u32 v5, vcc, 0, v5, vcc
  s_mov_b32 s46, 230400
  s_mov_b32 s47, 0
  global_load_dwordx4 v[48:51], v[4:5], off nt
  v_lshl_add_u64 v[4:5], v[4:5], 0, s[44:45]
  global_load_dwordx4 v[52:55], v[4:5], off nt
  v_lshl_add_u64 v[4:5], v[4:5], 0, s[44:45]
  global_load_dwordx4 v[56:59], v[4:5], off nt
  v_lshl_add_u64 v[4:5], v[4:5], 0, s[44:45]
  global_load_dwordx4 v[60:63], v[4:5], off nt
  v_lshl_add_u64 v[4:5], v[4:5], 0, s[44:45]
  global_load_dwordx4 v[64:67], v[4:5], off nt
  v_lshl_add_u64 v[4:5], v[4:5], 0, s[44:45]
  s_waitcnt vmcnt(4)
  global_load_dwordx4 v[68:71], v[4:5], off nt
  v_lshl_add_u64 v[4:5], v[4:5], 0, s[44:45]
  s_waitcnt vmcnt(4)
  global_load_dwordx4 v[72:75], v[4:5], off nt
  v_lshl_add_u64 v[4:5], v[4:5], 0, s[44:45]
  s_waitcnt vmcnt(4)
  global_load_dwordx4 v[76:79], v[4:5], off nt
  s_waitcnt vmcnt(0)
  v_perm_b32 v16, v52, v48, s60
  v_perm_b32 v17, v60, v56, s60
  v_perm_b32 v18, v68, v64, s60
  v_perm_b32 v19, v76, v72, s60
  v_perm_b32 v20, v52, v48, s61
  v_perm_b32 v21, v60, v56, s61
  v_perm_b32 v22, v68, v64, s61
  v_perm_b32 v23, v76, v72, s61
  v_perm_b32 v24, v53, v49, s60
  v_perm_b32 v25, v61, v57, s60
  v_perm_b32 v26, v69, v65, s60
  v_perm_b32 v27, v77, v73, s60
  v_perm_b32 v28, v53, v49, s61
  v_perm_b32 v29, v61, v57, s61
  v_perm_b32 v30, v69, v65, s61
  v_perm_b32 v31, v77, v73, s61
  v_perm_b32 v32, v54, v50, s60
  v_perm_b32 v33, v62, v58, s60
  v_perm_b32 v34, v70, v66, s60
  v_perm_b32 v35, v78, v74, s60
  v_perm_b32 v36, v54, v50, s61
  v_perm_b32 v37, v62, v58, s61
  v_perm_b32 v38, v70, v66, s61
  v_perm_b32 v39, v78, v74, s61
  v_perm_b32 v40, v55, v51, s60
  v_perm_b32 v41, v63, v59, s60
  v_perm_b32 v42, v71, v67, s60
  v_perm_b32 v43, v79, v75, s60
  v_perm_b32 v44, v55, v51, s61
  v_perm_b32 v45, v63, v59, s61
  v_perm_b32 v46, v71, v67, s61
  v_perm_b32 v47, v79, v75, s61
L_mF1:
  s_lshl_b32 s8, s9, 2
  s_min_u32 s6, s9, 1
  s_add_u32 s8, s8, s6
  s_add_u32 s8, s8, 1
  s_mul_i32 s6, s8, 294912
  s_mul_i32 s7, s4, 1152
  s_add_u32 s6, s6, s7
  s_lshl_b32 s7, s5, 7
  s_add_u32 s6, s6, s7
  v_and_b32 v5, 7, v0
  v_mul_u32_u24 v3, 73728, v1
  v_lshl_add_u32 v3, v5, 4, v3
  v_add_u32 v3, s6, v3
  v_and_b32 v5, 8, v0
  v_cmp_eq_u32 vcc, 0, v5
  v_mov_b32 v4, s30
  v_mov_b32 v5, s31
  v_mov_b32 v6, s28
  v_mov_b32 v7, s29
  v_cndmask_b32 v4, v4, v6, vcc
  v_cndmask_b32 v5, v5, v7, vcc
  v_add_co_u32 v4, vcc, v4, v3
  s_mov_b32 s44, 9216
  s_mov_b32 s45, 0
  v_addc_co_u32 v5, vcc, 0, v5, vcc
  s_mov_b32 s46, 230400
  s_mov_b32 s47, 0
  global_load_dwordx4 v[80:83], v[4:5], off nt
  v_lshl_add_u64 v[4:5], v[4:5], 0, s[44:45]
  global_load_dwordx4 v[84:87], v[4:5], off nt
  v_lshl_add_u64 v[4:5], v[4:5], 0, s[44:45]
  global_load_dwordx4 v[88:91], v[4:5], off nt
  v_lshl_add_u64 v[4:5], v[4:5], 0, s[44:45]
  global_load_dwordx4 v[92:95], v[4:5], off nt
  v_lshl_add_u64 v[4:5], v[4:5], 0, s[44:45]
  global_load_dwordx4 v[96:99], v[4:5], off nt
  v_lshl_add_u64 v[4:5], v[4:5], 0, s[44:45]
  s_waitcnt vmcnt(4)
  global_load_dwordx4 v[100:103], v[4:5], off nt
  v_lshl_add_u64 v[4:5], v[4:5], 0, s[44:45]
  s_waitcnt vmcnt(4)
  global_load_dwordx4 v[104:107], v[4:5], off nt
  v_lshl_add_u64 v[4:5], v[4:5], 0, s[44:45]
  s_waitcnt vmcnt(4)
  global_load_dwordx4 v[108:111], v[4:5], off nt
  s_waitcnt vmcnt(0)
  v_perm_b32 v48, v84, v80, s60
  v_perm_b32 v49, v92, v88, s60
  v_perm_b32 v50, v100, v96, s60
  v_perm_b32 v51, v108, v104, s60
  v_perm_b32 v52, v84, v80, s61
  v_perm_b32 v53, v92, v88, s61
  v_perm_b32 v54, v100, v96, s61
  v_perm_b32 v55, v108, v104, s61
  v_perm_b32 v56, v85, v81, s60
  v_perm_b32 v57, v93, v89, s60
  v_perm_b32 v58, v101, v97, s60
  v_perm_b32 v59, v109, v105, s60
  v_perm_b32 v60, v85, v81, s61
  v_perm_b32 v61, v93, v89, s61
  v_perm_b32 v62, v101, v97, s61
  v_perm_b32 v63, v109, v105, s61
  v_perm_b32 v64, v86, v82, s60
  v_perm_b32 v65, v94, v90, s60
  v_perm_b32 v66, v102, v98, s60
  v_perm_b32 v67, v110, v106, s60
  v_perm_b32 v68, v86, v82, s61
  v_perm_b32 v69, v94, v90, s61
  v_perm_b32 v70, v102, v98, s61
  v_perm_b32 v71, v110, v106, s61
  v_perm_b32 v72, v87, v83, s60
  v_perm_b32 v73, v95, v91, s60
  v_perm_b32 v74, v103, v99, s60
  v_perm_b32 v75, v111, v107, s60
  v_perm_b32 v76, v87, v83, s61
  v_perm_b32 v77, v95, v91, s61
  v_perm_b32 v78, v103, v99, s61
  v_perm_b32 v79, v111, v107, s61
L_mid2:
  v_and_b32 v5, 7, v0
  v_lshlrev_b32 v5, 2, v5
  s_mov_b32 s10, 31
  s_mov_b32 s11, 0
fl_41:
  buffer_load_dword v6, v5, s[52:55], 0 offen sc1
  s_waitcnt vmcnt(0)
  v_cmp_eq_u32 vcc, 0, v6
  s_and_b64 vcc, vcc, s[10:11]
  s_cbranch_scc0 fle_42
  s_sleep 8
  s_sub_u32 s15, s15, 1
  s_cbranch_scc0 fl_41
  s_mov_b32 s15, 0
fle_42:
  s_getreg_b32 s101, hwreg(HW_REG_XCC_ID)
  s_lshl_b32 s6, s4, 12
  s_add_u32 s0, s6, 270336
  s_cmp_lg_u32 s9, 0
  s_cbranch_scc1 L_xt1
  v_mov_b32 v10, 147456
  s_mov_b32 s58, 6600660
sp_43:
  ds_read_b32 v11, v10
  s_waitcnt lgkmcnt(0)
  v_readfirstlane_b32 s8, v11
  s_cmp_ge_u32 s8, 12
  s_cbranch_scc1 sp_43_ok
  s_sleep 32
  s_sub_u32 s58, s58, 1
  s_cbranch_scc0 sp_43
sp_43_ok:
  s_lshl_b32 s8, s5, 7
  v_mov_b32 v5, s8
  v_mov_b32 v6, s101
  s_mov_b64 exec, 1
  buffer_store_dword v6, v5, s[48:51], s0 offen sc1
  s_mov_b64 exec, -1
L_xt1:
  v_lshlrev_b32 v248, 4, v0
  v_lshrrev_b32 v5, 5, v0
  v_lshlrev_b32 v251, 3, v0
  v_mul_u32_u24 v5, 18432, v5
  v_and_b32 v6, 31, v0
  v_lshl_add_u32 v253, v6, 3, v5
  s_movk_i32 s96, 256
  v_mov_b32 v10, 147456
  v_and_b32 v249, 7, v0
  v_lshlrev_b32 v249, 4, v249
  v_lshl_add_u32 v249, v1, 7, v249
  v_bfe_u32 v250, v0, 3, 1
  v_lshl_add_u32 v250, v250, 9, v249
  s_cmp_lg_u32 s5, 31
  s_cbranch_scc1 L_par_e
  s_cmp_lg_u32 s9, 2
  s_cbranch_scc1 L_par_e
  s_mov_b32 s58, 3384094
sp_44:
  ds_read_b32 v11, v10
  s_waitcnt lgkmcnt(0)
  v_readfirstlane_b32 s8, v11
  s_cmp_ge_u32 s8, 60
  s_cbranch_scc1 sp_44_ok
  s_sleep 64
  s_sub_u32 s58, s58, 1
  s_cbranch_scc0 sp_44
sp_44_ok:
  s_lshl_b32 s8, s4, 10
  s_add_u32 s8, s8, 475136
  s_mov_b32 s12, -1
  s_mov_b32 s13, -1
  s_mov_b32 s58, 23
L_par:
  s_memtime s[6:7]
  s_waitcnt lgkmcnt(0)
  s_load_dword s56, s[42:43], s8 glc
  s_waitcnt lgkmcnt(0)
  s_memtime s[10:11]
  s_waitcnt lgkmcnt(0)
  s_sub_u32 s6, s10, s6
  s_min_u32 s6, s6, s12
  s_mov_b32 s12, s13
  s_mov_b32 s13, s6
  s_add_u32 s8, s8, 8192
  s_sub_u32 s58, s58, 1
  s_cbranch_scc0 L_par
  s_cmp_lt_u32 s13, s12
  s_cselect_b32 s14, 8192, 0
  v_mov_b32 v5, 3976
  v_mov_b32 v6, s14
  s_mov_b64 exec, 1
  buffer_store_dword v6, v5, s[48:51], s0 offen sc1
  s_mov_b64 exec, -1
L_par_e:
  s_cmp_lg_u32 s9, 1
  s_cbranch_scc1 fb_45
  v_mov_b32 v12, 147632
  s_mov_b32 s58, 12578616
sp_46:
  ds_read_b32 v11, v12
  s_waitcnt lgkmcnt(0)
  v_readfirstlane_b32 s56, v11
  s_cmp_lg_u32 s56, 0
  s_cbranch_scc1 sp_46_ok
  s_sleep 16
  s_sub_u32 s58, s58, 1
  s_cbranch_scc0 sp_46
sp_46_ok:
  s_and_b32 s8, s5, 3
  s_cmp_lg_u32 s8, 0
  s_cbranch_scc1 fb_45_n
  s_lshl_b32 s8, s5, 7
  v_mov_b32 v5, s8
  v_mov_b32 v6, s56
  s_mov_b64 exec, 1
  buffer_store_dword v6, v5, s[48:51], s0 offen offset:16 sc1
  s_mov_b64 exec, -1
fb_45_n:
  s_lshl_b32 s57, s4, 8
  s_add_u32 s57, s57, 459776
  v_mov_b32 v4, 0
  s_cmp_lg_u32 s5, 31
  s_cbranch_scc1 fb_45_c
  buffer_load_dword v6, v4, s[48:51], s57 offen sc1
  s_mov_b32 s58, 12578616
sp_47:
  ds_read_b32 v11, v10
  s_waitcnt lgkmcnt(0)
  v_readfirstlane_b32 s8, v11
  s_cmp_ge_u32 s8, 57
  s_cbranch_scc1 sp_47_ok
  s_sleep 16
  s_sub_u32 s58, s58, 1
  s_cbranch_scc0 sp_47
sp_47_ok:
  v_and_b32 v5, 7, v0
  v_lshlrev_b32 v5, 12, v5
  v_lshrrev_b32 v6, 3, v0
  v_lshl_add_u32 v5, v6, 9, v5
  s_mov_b32 s8, 270352
  buffer_load_dword v6, v5, s[48:51], s8 offen sc1
  s_waitcnt vmcnt(0)
  v_cmp_ne_u32 vcc, -1, v6
  v_sub_u32 v6, s56, v6
  v_bfe_i32 v6, v6, 0, 20
  v_cvt_f32_i32 v6, v6
  v_mov_b32 v7, 0xc3c80000
  v_mov_b32 v8, 0x43c80000
  v_med3_f32 v6, v6, v7, v8
  v_cndmask_b32 v6, 0, v6, vcc
  s_bcnt1_i32_b64 s8, vcc
  s_max_u32 s8, s8, 1
  v_cvt_f32_u32 v8, s8
  v_rcp_f32 v8, v8
  s_nop 1
  v_add_f32 v6, v6, v6 row_ror:1 row_mask:0xf bank_mask:0xf
  s_nop 1
  v_add_f32 v6, v6, v6 row_ror:2 row_mask:0xf bank_mask:0xf
  s_nop 1
  v_add_f32 v6, v6, v6 row_ror:4 row_mask:0xf bank_mask:0xf
  s_nop 1
  v_add_f32 v6, v6, v6 row_ror:8 row_mask:0xf bank_mask:0xf
  v_mov_b32 v7, v6
  s_nop 1
  v_permlane16_swap_b32 v6, v7
  v_add_f32 v6, v6, v7
  v_mov_b32 v7, v6
  s_nop 1
  v_permlane32_swap_b32 v6, v7
  v_add_f32 v6, v6, v7
  v_mul_f32 v6, v6, v8
  v_cvt_i32_f32 v6, v6
  v_sub_u32 v6, s56, v6
  ds_read_b32 v9, v12 offset:40
  s_waitcnt lgkmcnt(0)
  v_sub_u32 v9, v6, v9
  v_mov_b32 v7, 13900
  v_mov_b32 v252, v9
  v_mul_u32_u24 v8, 26, v7
  v_lshrrev_b32 v8, 8, v8
  v_sub_u32 v6, v6, v8
  s_mov_b64 exec, 1
  buffer_store_dwordx2 v[6:7], v4, s[48:51], s57 offen
  s_branch fb_45_d
fb_45_c:
  s_mov_b32 s58, 12578616
sp_48:
  ds_read_b32 v11, v10
  s_waitcnt lgkmcnt(0)
  v_readfirstlane_b32 s8, v11
  s_cmp_ge_u32 s8, 61
  s_cbranch_scc1 sp_48_ok
  s_sleep 16
  s_sub_u32 s58, s58, 1
  s_cbranch_scc0 sp_48
sp_48_ok:
  s_mov_b32 s58, 8
  s_mov_b64 exec, 1
fb_45_p:
  buffer_load_dwordx2 v[6:7], v4, s[48:51], s57 offen sc1
  s_waitcnt vmcnt(0)
  v_readfirstlane_b32 s8, v7
  s_cmp_lg_u32 s8, -1
  s_cbranch_scc1 fb_45_d
  s_sleep 16
  s_sub_u32 s58, s58, 1
  s_cbranch_scc0 fb_45_p
  s_branch fb_45_e
fb_45_d:
  v_mov_b32 v9, 147512
  ds_write_b64 v9, v[6:7]
fb_45_e:
  s_mov_b64 exec, -1
fb_45:
  s_cmp_lg_u32 s9, 1
  s_cbranch_scc1 fb_49
  v_mov_b32 v12, 147636
  s_mov_b32 s58, 12578616
sp_50:
  ds_read_b32 v11, v12
  s_waitcnt lgkmcnt(0)
  v_readfirstlane_b32 s56, v11
  s_cmp_lg_u32 s56, 0
  s_cbranch_scc1 sp_50_ok
  s_sleep 16
  s_sub_u32 s58, s58, 1
  s_cbranch_scc0 sp_50
sp_50_ok:
  s_and_b32 s8, s5, 3
  s_cmp_lg_u32 s8, 1
  s_cbranch_scc1 fb_49_n
  s_lshl_b32 s8, s5, 7
  v_mov_b32 v5, s8
  v_mov_b32 v6, s56
  s_mov_b64 exec, 1
  buffer_store_dword v6, v5, s[48:51], s0 offen offset:16 sc1
  s_mov_b64 exec, -1
fb_49_n:
  s_lshl_b32 s57, s4, 8
  s_add_u32 s57, s57, 459784
  v_mov_b32 v4, 0
  s_cmp_lg_u32 s5, 31
  s_cbranch_scc1 fb_49_c
  buffer_load_dword v6, v4, s[48:51], s57 offen sc1
  s_mov_b32 s58, 12578616
sp_51:
  ds_read_b32 v11, v10
  s_waitcnt lgkmcnt(0)
  v_readfirstlane_b32 s8, v11
  s_cmp_ge_u32 s8, 95
  s_cbranch_scc1 sp_51_ok
  s_sleep 16
  s_sub_u32 s58, s58, 1
  s_cbranch_scc0 sp_51
sp_51_ok:
  v_and_b32 v5, 7, v0
  v_lshlrev_b32 v5, 12, v5
  v_lshrrev_b32 v6, 3, v0
  v_lshl_add_u32 v5, v6, 9, v5
  s_mov_b32 s8, 270480
  buffer_load_dword v6, v5, s[48:51], s8 offen sc1
  s_waitcnt vmcnt(0)
  v_cmp_ne_u32 vcc, -1, v6
  v_sub_u32 v6, s56, v6
  v_bfe_i32 v6, v6, 0, 20
  v_cvt_f32_i32 v6, v6
  v_mov_b32 v7, 0xc3c80000
  v_mov_b32 v8, 0x43c80000
  v_med3_f32 v6, v6, v7, v8
  v_cndmask_b32 v6, 0, v6, vcc
  s_bcnt1_i32_b64 s8, vcc
  s_max_u32 s8, s8, 1
  v_cvt_f32_u32 v8, s8
  v_rcp_f32 v8, v8
  s_nop 1
  v_add_f32 v6, v6, v6 row_ror:1 row_mask:0xf bank_mask:0xf
  s_nop 1
  v_add_f32 v6, v6, v6 row_ror:2 row_mask:0xf bank_mask:0xf
  s_nop 1
  v_add_f32 v6, v6, v6 row_ror:4 row_mask:0xf bank_mask:0xf
  s_nop 1
  v_add_f32 v6, v6, v6 row_ror:8 row_mask:0xf bank_mask:0xf
  v_mov_b32 v7, v6
  s_nop 1
  v_permlane16_swap_b32 v6, v7
  v_add_f32 v6, v6, v7
  v_mov_b32 v7, v6
  s_nop 1
  v_permlane32_swap_b32 v6, v7
  v_add_f32 v6, v6, v7
  v_mul_f32 v6, v6, v8
  v_cvt_i32_f32 v6, v6
  v_sub_u32 v6, s56, v6
  ds_read_b32 v9, v12 offset:40
  s_waitcnt lgkmcnt(0)
  v_sub_u32 v9, v6, v9
  v_sub_u32 v7, v9, v252
  v_bfe_i32 v7, v7, 0, 20
  v_cvt_f32_i32 v7, v7
  v_mul_f32 v7, 0x414ccccd, v7
  v_cvt_i32_f32 v7, v7
  v_max_i32 v7, 10240, v7
  v_min_i32 v7, 30720, v7
  v_mov_b32 v252, v9
  v_mul_u32_u24 v8, 46, v7
  v_lshrrev_b32 v8, 8, v8
  v_sub_u32 v6, v6, v8
  s_mov_b64 exec, 1
  buffer_store_dwordx2 v[6:7], v4, s[48:51], s57 offen
  s_branch fb_49_d
fb_49_c:
  s_mov_b32 s58, 12578616
sp_52:
  ds_read_b32 v11, v10
  s_waitcnt lgkmcnt(0)
  v_readfirstlane_b32 s8, v11
  s_cmp_ge_u32 s8, 99
  s_cbranch_scc1 sp_52_ok
  s_sleep 16
  s_sub_u32 s58, s58, 1
  s_cbranch_scc0 sp_52
sp_52_ok:
  s_mov_b32 s58, 8
  s_mov_b64 exec, 1
fb_49_p:
  buffer_load_dwordx2 v[6:7], v4, s[48:51], s57 offen sc1
  s_waitcnt vmcnt(0)
  v_readfirstlane_b32 s8, v7
  s_cmp_lg_u32 s8, -1
  s_cbranch_scc1 fb_49_d
  s_sleep 16
  s_sub_u32 s58, s58, 1
  s_cbranch_scc0 fb_49_p
  s_branch fb_49_e
fb_49_d:
  v_mov_b32 v9, 147512
  ds_write_b64 v9, v[6:7]
fb_49_e:
  s_mov_b64 exec, -1
fb_49:
  s_cmp_lg_u32 s9, 1
  s_cbranch_scc1 fb_53
  v_mov_b32 v12, 147640
  s_mov_b32 s58, 12578616
sp_54:
  ds_read_b32 v11, v12
  s_waitcnt lgkmcnt(0)
  v_readfirstlane_b32 s56, v11
  s_cmp_lg_u32 s56, 0
  s_cbranch_scc1 sp_54_ok
  s_sleep 16
  s_sub_u32 s58, s58, 1
  s_cbranch_scc0 sp_54
sp_54_ok:
  s_and_b32 s8, s5, 3
  s_cmp_lg_u32 s8, 2
  s_cbranch_scc1 fb_53_n
  s_lshl_b32 s8, s5, 7
  v_mov_b32 v5, s8
  v_mov_b32 v6, s56
  s_mov_b64 exec, 1
  buffer_store_dword v6, v5, s[48:51], s0 offen offset:16 sc1
  s_mov_b64 exec, -1
fb_53_n:
  s_lshl_b32 s57, s4, 8
  s_add_u32 s57, s57, 459792
  v_mov_b32 v4, 0
  s_cmp_lg_u32 s5, 31
  s_cbranch_scc1 fb_53_c
  buffer_load_dword v6, v4, s[48:51], s57 offen sc1
  s_mov_b32 s58, 12578616
sp_55:
  ds_read_b32 v11, v10
  s_waitcnt lgkmcnt(0)
  v_readfirstlane_b32 s8, v11
  s_cmp_ge_u32 s8, 135
  s_cbranch_scc1 sp_55_ok
  s_sleep 16
  s_sub_u32 s58, s58, 1
  s_cbranch_scc0 sp_55
sp_55_ok:
  v_and_b32 v5, 7, v0
  v_lshlrev_b32 v5, 12, v5
  v_lshrrev_b32 v6, 3, v0
  v_lshl_add_u32 v5, v6, 9, v5
  s_mov_b32 s8, 270608
  buffer_load_dword v6, v5, s[48:51], s8 offen sc1
  s_waitcnt vmcnt(0)
  v_cmp_ne_u32 vcc, -1, v6
  v_sub_u32 v6, s56, v6
  v_bfe_i32 v6, v6, 0, 20
  v_cvt_f32_i32 v6, v6
  v_mov_b32 v7, 0xc3c80000
  v_mov_b32 v8, 0x43c80000
  v_med3_f32 v6, v6, v7, v8
  v_cndmask_b32 v6, 0, v6, vcc
  s_bcnt1_i32_b64 s8, vcc
  s_max_u32 s8, s8, 1
  v_cvt_f32_u32 v8, s8
  v_rcp_f32 v8, v8
  s_nop 1
  v_add_f32 v6, v6, v6 row_ror:1 row_mask:0xf bank_mask:0xf
  s_nop 1
  v_add_f32 v6, v6, v6 row_ror:2 row_mask:0xf bank_mask:0xf
  s_nop 1
  v_add_f32 v6, v6, v6 row_ror:4 row_mask:0xf bank_mask:0xf
  s_nop 1
  v_add_f32 v6, v6, v6 row_ror:8 row_mask:0xf bank_mask:0xf
  v_mov_b32 v7, v6
  s_nop 1
  v_permlane16_swap_b32 v6, v7
  v_add_f32 v6, v6, v7
  v_mov_b32 v7, v6
  s_nop 1
  v_permlane32_swap_b32 v6, v7
  v_add_f32 v6, v6, v7
  v_mul_f32 v6, v6, v8
  v_cvt_i32_f32 v6, v6
  v_sub_u32 v6, s56, v6
  ds_read_b32 v9, v12 offset:40
  s_waitcnt lgkmcnt(0)
  v_sub_u32 v9, v6, v9
  v_sub_u32 v7, v9, v252
  v_bfe_i32 v7, v7, 0, 20
  v_cvt_f32_i32 v7, v7
  v_mul_f32 v7, 0x414ccccd, v7
  v_cvt_i32_f32 v7, v7
  v_max_i32 v7, 10240, v7
  v_min_i32 v7, 30720, v7
  v_mov_b32 v252, v9
  v_mul_u32_u24 v8, 66, v7
  v_lshrrev_b32 v8, 8, v8
  v_sub_u32 v6, v6, v8
  s_mov_b64 exec, 1
  buffer_store_dwordx2 v[6:7], v4, s[48:51], s57 offen
  s_branch fb_53_d
fb_53_c:
  s_mov_b32 s58, 12578616
sp_56:
  ds_read_b32 v11, v10
  s_waitcnt lgkmcnt(0)
  v_readfirstlane_b32 s8, v11
  s_cmp_ge_u32 s8, 139
  s_cbranch_scc1 sp_56_ok
  s_sleep 16
  s_sub_u32 s58, s58, 1
  s_cbranch_scc0 sp_56
sp_56_ok:
  s_mov_b32 s58, 8
  s_mov_b64 exec, 1
fb_53_p:
  buffer_load_dwordx2 v[6:7], v4, s[48:51], s57 offen sc1
  s_waitcnt vmcnt(0)
  v_readfirstlane_b32 s8, v7
  s_cmp_lg_u32 s8, -1
  s_cbranch_scc1 fb_53_d
  s_sleep 16
  s_sub_u32 s58, s58, 1
  s_cbranch_scc0 fb_53_p
  s_branch fb_53_e
fb_53_d:
  v_mov_b32 v9, 147512
  ds_write_b64 v9, v[6:7]
fb_53_e:
  s_mov_b64 exec, -1
fb_53:
  s_mov_b32 s58, 3384094
sp_57:
  ds_read_b32 v11, v10
  s_waitcnt lgkmcnt(0)
  v_readfirstlane_b32 s8, v11
  s_cmp_ge_u32 s8, 150
  s_cbranch_scc1 sp_57_ok
  s_sleep 64
  s_sub_u32 s58, s58, 1
  s_cbranch_scc0 sp_57
sp_57_ok:
  s_cmp_lt_u32 s5, 13
  s_cbranch_scc1 L_nohint
  v_mov_b32 v5, 3976
  s_mov_b64 exec, 1
  buffer_load_dword v6, v5, s[48:51], s0 offen sc1
  s_mov_b64 exec, -1
  s_waitcnt vmcnt(0)
  v_readfirstlane_b32 s14, v6
  s_and_b32 s14, s14, 8192
L_nohint:
  s_cmp_lt_u32 s5, 22
  s_cbranch_scc1 L_mid3
  s_cmp_ge_u32 s5, 30
  s_cbranch_scc1 L_mid3
  s_sub_u32 s56, s5, 22
  s_mul_i32 s6, s56, 1152
  s_mul_i32 s8, s9, 384
  s_add_u32 s6, s6, s8
  v_lshlrev_b32 v5, 3, v0
  v_mov_b32 v176, 0
  v_mov_b32 v177, 0
  v_mov_b32 v178, 0
  v_mov_b32 v179, 0
  v_mov_b32 v180, 0
  v_mov_b32 v181, 0
  v_mov_b32 v182, 0
  v_mov_b32 v183, 0
  s_mov_b32 s44, s16
  s_mov_b32 s45, s17
  s_mov_b32 s46, 9216
  s_mov_b32 s47, 0x20000
  s_mov_b32 s10, -1
  s_mov_b32 s11, 0xffff
  s_cmp_eq_u32 s9, 3
  s_cbranch_scc1 L_mid3
  s_mov_b64 exec, s[10:11]
  buffer_load_dwordx2 v[176:177], v5, s[44:47], s6 offen
  s_add_u32 s6, s6, 86016
  s_add_u32 s7, s6, 9216
  s_add_u32 s8, s6, 18432
po_58:
  buffer_load_dwordx2 v[178:179], v5, s[48:51], s6 offen sc1
  buffer_load_dwordx2 v[180:181], v5, s[48:51], s7 offen sc1
  buffer_load_dwordx2 v[182:183], v5, s[48:51], s8 offen sc1
  s_waitcnt vmcnt(2)
  v_max_u32 v6, v178, v179
  s_waitcnt vmcnt(1)
  v_max3_u32 v6, v6, v180, v181
  s_waitcnt vmcnt(0)
  v_max3_u32 v6, v6, v182, v183
  v_cmp_eq_u32 vcc, -1, v6
  s_cbranch_vccz poe_59
  s_sleep 8
  s_sub_u32 s15, s15, 1
  s_cbranch_scc0 po_58
  s_mov_b32 s15, 0
poe_59:
  s_mov_b64 exec, -1
  v_lshlrev_b32 v228, 16, v176
  v_and_b32 v229, 0xffff0000, v176
  v_lshlrev_b32 v230, 16, v177
  v_and_b32 v231, 0xffff0000, v177
  v_lshlrev_b32 v232, 16, v178
  v_and_b32 v233, 0xffff0000, v178
  v_lshlrev_b32 v234, 16, v179
  v_and_b32 v235, 0xffff0000, v179
  v_lshlrev_b32 v236, 16, v180
  v_and_b32 v237, 0xffff0000, v180
  v_lshlrev_b32 v238, 16, v181
  v_and_b32 v239, 0xffff0000, v181
  v_lshlrev_b32 v240, 16, v182
  v_and_b32 v241, 0xffff0000, v182
  v_lshlrev_b32 v242, 16, v183
  v_and_b32 v243, 0xffff0000, v183
  v_add_f32 v240, 1.0, v240
  v_add_f32 v241, 1.0, v241
  v_add_f32 v242, 1.0, v242
  v_add_f32 v243, 1.0, v243
  v_cvt_pk_bf16_f32 v6, v240, v241
  v_lshlrev_b32 v240, 16, v6
  v_and_b32 v241, 0xffff0000, v6
  v_cvt_pk_bf16_f32 v6, v242, v243
  v_lshlrev_b32 v242, 16, v6
  v_and_b32 v243, 0xffff0000, v6
L_mid3:
  v_lshlrev_b32 v246, 3, v2
  v_lshl_add_u32 v246, v1, 1, v246
  v_and_b32 v245, 0xfc, v246
  s_cmp_lt_u32 s5, 13
  s_cbranch_scc1 L_mid4
  s_cmp_ge_u32 s5, 22
  s_cbranch_scc1 L_mid4
  s_cmp_lg_u32 s9, 3
  s_cbranch_scc1 L_mid4
  s_mul_i32 s6, s4, 1152
  s_sub_u32 s8, s5, 13
  s_lshl_b32 s8, s8, 7
  s_add_u32 s59, s6, s8
  s_add_u32 s6, s59, 113664
po_60:
  buffer_load_dword v244, v245, s[48:51], s6 offen sc1
  s_waitcnt vmcnt(0)
  v_mov_b32 v6, v244
  v_cmp_eq_u32 vcc, -1, v6
  s_cbranch_vccz poe_61
  s_sleep 8
  s_sub_u32 s15, s15, 1
  s_cbranch_scc0 po_60
  s_mov_b32 s15, 0
poe_61:
  v_and_b32 v5, 1, v1
  v_cmp_eq_u32 vcc, 1, v5
  v_lshlrev_b32 v5, 16, v244
  v_and_b32 v244, 0xffff0000, v244
  v_cndmask_b32 v244, v5, v244, vcc
  s_mul_i32 s8, s4, 9
  s_add_u32 s8, s8, s5
  s_sub_u32 s8, s8, 13
  s_lshr_b32 s13, s8, 2
  s_lshl_b32 s13, s13, 14
  s_and_b32 s8, s8, 3
  s_lshl_b32 s8, s8, 11
  s_add_u32 s13, s13, s8
  s_add_u32 s13, s13, s14
  s_add_u32 s13, s13, 770048
  v_mov_b32 v212, -1
  v_mov_b32 v213, -1
  v_mov_b32 v214, -1
  v_mov_b32 v215, -1
  buffer_store_dwordx4 v[212:215], v248, s[48:51], s13 offen sc1
  buffer_store_dwordx4 v[212:215], v248, s[48:51], s13 offen offset:1024 sc1
  s_waitcnt vmcnt(0)
L_mid4:
  v_mov_b32 v12, 147496
  s_cmp_lg_u32 s9, 3
  s_cbranch_scc1 L_noloc
  v_and_b32 v5, 31, v0
  v_lshlrev_b32 v5, 7, v5
po_62:
  buffer_load_dword v7, v5, s[48:51], s0 offen sc1
  s_waitcnt vmcnt(0)
  v_mov_b32 v6, v7
  v_cmp_eq_u32 vcc, -1, v6
  s_cbranch_vccz poe_63
  s_sleep 32
  s_sub_u32 s15, s15, 1
  s_cbranch_scc0 po_62
  s_mov_b32 s15, 0
poe_63:
  v_cmp_ne_u32 vcc, s101, v7
  s_cmp_eq_u64 vcc, 0
  s_cselect_b32 s100, 1, 2
  v_mov_b32 v6, s100
  ds_write_b32 v12, v6
L_noloc:
  s_mov_b32 s58, 12578616
sp_64:
  ds_read_b32 v11, v12
  s_waitcnt lgkmcnt(0)
  v_readfirstlane_b32 s100, v11
  s_cmp_lg_u32 s100, 0
  s_cbranch_scc1 sp_64_ok
  s_sleep 16
  s_sub_u32 s58, s58, 1
  s_cbranch_scc0 sp_64
sp_64_ok:
  s_mov_b32 s1, 0
  s_mov_b32 s50, 0
L_tail:
  v_mov_b32 v10, 147456
  s_cmp_lt_u32 s5, 9
  s_cbranch_scc1 L_tF
  s_cmp_lt_u32 s5, 22
  s_cbranch_scc1 L_tH
  s_cmp_ge_u32 s5, 31
  s_cbranch_scc1 L_tY
  s_lshl_b32 s7, s4, 2
  s_add_u32 s7, s7, s9
  s_lshl_b32 s6, s7, 12
  s_add_u32 s6, s6, 122880
  v_and_b32 v5, 8, v0
  v_mul_u32_u24 v5, 268, v5
  v_sub_u32 v7, v13, v5
  v_lshrrev_b32 v5, 5, v0
  v_mul_u32_u24 v5, 9, v5
  s_mul_i32 s8, s9, 18
  s_add_u32 s8, s8, s5
  s_sub_u32 s8, s8, 22
  v_add_u32 v5, s8, v5
  v_lshrrev_b32 v6, 2, v5
  v_and_b32 v5, 3, v5
  v_lshlrev_b32 v5, 11, v5
  v_lshl_add_u32 v5, v6, 14, v5
  v_and_b32 v6, 31, v0
  v_lshl_add_u32 v253, v6, 3, v5
  s_lshl_b32 s57, s4, 8
  s_add_u32 s57, s57, 475136
  s_add_u32 s3, s57, 8192
  s_sub_u32 s97, s96, 24
  s_and_b32 s97, s97, s1
  s_mov_b32 s58, 3384094
sp_65:
  ds_read_b32 v11, v10
  s_waitcnt lgkmcnt(0)
  v_readfirstlane_b32 s8, v11
  s_cmp_ge_u32 s8, s97
  s_cbranch_scc1 sp_65_ok
  s_sleep 64
  s_sub_u32 s58, s58, 1
  s_cbranch_scc0 sp_65
sp_65_ok:
  s_sub_u32 s97, s96, 0
  s_and_b32 s97, s97, s1
  s_mov_b32 s58, 60606060
sp_66:
  ds_read_b32 v11, v10
  s_waitcnt lgkmcnt(0)
  v_readfirstlane_b32 s8, v11
  s_cmp_ge_u32 s8, s97
  s_cbranch_scc1 sp_66_ok
  s_sleep 2
  s_sub_u32 s58, s58, 1
  s_cbranch_scc0 sp_66
sp_66_ok:
po_67:
  buffer_load_dwordx4 v[176:179], v248, s[48:51], s6 offen offset:0 sc1
  buffer_load_dwordx4 v[180:183], v248, s[48:51], s6 offen offset:1024 sc1
  buffer_load_dwordx4 v[184:187], v248, s[48:51], s6 offen offset:2048 sc1
  buffer_load_dwordx4 v[188:191], v248, s[48:51], s6 offen offset:3072 sc1
  s_waitcnt vmcnt(3)
  v_max3_u32 v6, v176, v177, v178
  v_max_u32 v6, v6, v179
  s_waitcnt vmcnt(2)
  v_max3_u32 v6, v6, v180, v181
  v_max3_u32 v6, v6, v182, v183
  s_waitcnt vmcnt(1)
  v_max3_u32 v6, v6, v184, v185
  v_max3_u32 v6, v6, v186, v187
  s_waitcnt vmcnt(0)
  v_max3_u32 v6, v6, v188, v189
  v_max3_u32 v6, v6, v190, v191
  v_cmp_eq_u32 vcc, -1, v6
  s_cbranch_vccz poe_68
  s_sub_u32 s15, s15, 1
  s_cbranch_scc0 po_67
  s_mov_b32 s15, 0
poe_68:
  v_mfma_f32_16x16x32_bf16 v[212:215], v[16:19], v[176:179], 0
  v_mfma_f32_16x16x32_bf16 v[216:219], v[20:23], v[176:179], 0
  v_mfma_f32_16x16x32_bf16 v[220:223], v[24:27], v[176:179], 0
  v_mfma_f32_16x16x32_bf16 v[224:227], v[28:31], v[176:179], 0
  v_mfma_f32_16x16x32_bf16 v[212:215], v[32:35], v[180:183], v[212:215]
  v_mfma_f32_16x16x32_bf16 v[216:219], v[36:39], v[180:183], v[216:219]
  v_mfma_f32_16x16x32_bf16 v[220:223], v[40:43], v[180:183], v[220:223]
  v_mfma_f32_16x16x32_bf16 v[224:227], v[44:47], v[180:183], v[224:227]
  v_mfma_f32_16x16x32_bf16 v[212:215], v[48:51], v[184:187], v[212:215]
  v_mfma_f32_16x16x32_bf16 v[216:219], v[52:55], v[184:187], v[216:219]
  v_mfma_f32_16x16x32_bf16 v[220:223], v[56:59], v[184:187], v[220:223]
  v_mfma_f32_16x16x32_bf16 v[224:227], v[60:63], v[184:187], v[224:227]
  v_mfma_f32_16x16x32_bf16 v[212:215], v[64:67], v[188:191], v[212:215]
  v_mfma_f32_16x16x32_bf16 v[216:219], v[68:71], v[188:191], v[216:219]
  v_mfma_f32_16x16x32_bf16 v[220:223], v[72:75], v[188:191], v[220:223]
  v_mfma_f32_16x16x32_bf16 v[224:227], v[76:79], v[188:191], v[224:227]
  s_nop 4
  v_add_f32 v176, v212, v212 row_ror:8 row_mask:0xf bank_mask:0x3
  v_add_f32 v177, v213, v213 row_ror:8 row_mask:0xf bank_mask:0x3
  v_add_f32 v178, v214, v214 row_ror:8 row_mask:0xf bank_mask:0x3
  v_add_f32 v179, v215, v215 row_ror:8 row_mask:0xf bank_mask:0x3
  v_add_f32 v180, v216, v216 row_ror:8 row_mask:0xf bank_mask:0x3
  v_add_f32 v181, v217, v217 row_ror:8 row_mask:0xf bank_mask:0x3
  v_add_f32 v182, v218, v218 row_ror:8 row_mask:0xf bank_mask:0x3
  v_add_f32 v183, v219, v219 row_ror:8 row_mask:0xf bank_mask:0x3
  v_add_f32 v176, v220, v220 row_ror:8 row_mask:0xf bank_mask:0xc
  v_add_f32 v177, v221, v221 row_ror:8 row_mask:0xf bank_mask:0xc
  v_add_f32 v178, v222, v222 row_ror:8 row_mask:0xf bank_mask:0xc
  v_add_f32 v179, v223, v223 row_ror:8 row_mask:0xf bank_mask:0xc
  v_add_f32 v180, v224, v224 row_ror:8 row_mask:0xf bank_mask:0xc
  v_add_f32 v181, v225, v225 row_ror:8 row_mask:0xf bank_mask:0xc
  v_add_f32 v182, v226, v226 row_ror:8 row_mask:0xf bank_mask:0xc
  v_add_f32 v183, v227, v227 row_ror:8 row_mask:0xf bank_mask:0xc
  ds_write_b128 v7, v[176:179]
  ds_write_b128 v7, v[180:183] offset:16
  s_waitcnt lgkmcnt(0)
  s_cmp_eq_u32 s1, 0
  s_cbranch_scc1 hb_69
  s_barrier
hb_69:
  ds_read_b32 v212, v15 offset:0
  ds_read_b32 v213, v15 offset:16
  ds_read_b32 v214, v15 offset:2176
  ds_read_b32 v215, v15 offset:2192
  ds_read_b32 v216, v15 offset:4352
  ds_read_b32 v217, v15 offset:4368
  ds_read_b32 v218, v15 offset:6528
  ds_read_b32 v219, v15 offset:6544
  s_waitcnt lgkmcnt(4)
  v_add_f32 v212, v212, v214
  v_add_f32 v213, v213, v215
  s_waitcnt lgkmcnt(0)
  v_add_f32 v216, v216, v218
  v_add_f32 v217, v217, v219
  v_add_f32 v10, v212, v216
  v_add_f32 v11, v213, v217
  buffer_store_dwordx2 v[10:11], v253, s[48:51], s57 offen sc1
  buffer_store_dwordx2 v[10:11], v253, s[48:51], s3 offen sc1
  s_cmp_ge_u32 s5, 30
  s_cbranch_scc1 L_fin
  s_cmp_eq_u32 s9, 3
  s_cbranch_scc1 L_fin
  s_sub_u32 s56, s5, 22
  s_mul_i32 s6, s56, 9
  s_mul_i32 s8, s9, 3
  s_add_u32 s6, s6, s8
  v_add_u32 v117, s6, v1
  v_lshrrev_b32 v5, 2, v117
  v_and_b32 v117, 3, v117
  v_lshlrev_b32 v117, 11, v117
  v_lshl_add_u32 v117, v5, 14, v117
  v_lshl_add_u32 v117, v2, 4, v117
  s_add_u32 s6, s14, 475136
  s_lshl_b32 s8, s9, 3
  s_add_u32 s8, s8, 147520
  v_mov_b32 v112, s8
  v_mov_b32 v113, 147520
  s_mul_i32 s8, s9, 384
  s_mul_i32 s99, s56, 1152
  s_add_u32 s99, s99, s8
  s_mul_i32 s98, s4, 9216
  s_mul_i32 s8, s9, 3072
  s_add_u32 s98, s98, s8
  s_lshl_b32 s8, s56, 4
  s_add_u32 s98, s98, s8
  s_add_u32 s98, s98, 303104
  v_lshrrev_b32 v116, 1, v0
  v_lshlrev_b32 v116, 7, v116
  v_and_b32 v5, 1, v0
  v_lshl_add_u32 v116, v5, 3, v116
  s_add_u32 s99, s99, 376832
  v_mov_b32 v8, 0
  v_mov_b32 v9, 0
  s_mov_b32 s10, -1
  s_mov_b32 s11, 0xffff
  s_mov_b64 exec, s[10:11]
  s_waitcnt vmcnt(0)
po_70:
  buffer_load_dwordx4 v[176:179], v117, s[48:51], s6 offen offset:0 sc1
  buffer_load_dwordx4 v[180:183], v117, s[48:51], s6 offen offset:256 sc1
  buffer_load_dwordx4 v[184:187], v117, s[48:51], s6 offen offset:512 sc1
  buffer_load_dwordx4 v[188:191], v117, s[48:51], s6 offen offset:768 sc1
  buffer_load_dwordx4 v[192:195], v117, s[48:51], s6 offen offset:1024 sc1
  buffer_load_dwordx4 v[196:199], v117, s[48:51], s6 offen offset:1280 sc1
  buffer_load_dwordx4 v[200:203], v117, s[48:51], s6 offen offset:1536 sc1
  buffer_load_dwordx4 v[204:207], v117, s[48:51], s6 offen offset:1792 sc1
  s_waitcnt vmcnt(7)
  v_max3_u32 v6, v176, v177, v178
  v_max_u32 v6, v6, v179
  s_waitcnt vmcnt(6)
  v_max3_u32 v6, v6, v180, v181
  v_max3_u32 v6, v6, v182, v183
  s_waitcnt vmcnt(5)
  v_max3_u32 v6, v6, v184, v185
  v_max3_u32 v6, v6, v186, v187
  s_waitcnt vmcnt(4)
  v_max3_u32 v6, v6, v188, v189
  v_max3_u32 v6, v6, v190, v191
  s_waitcnt vmcnt(3)
  v_max3_u32 v6, v6, v192, v193
  v_max3_u32 v6, v6, v194, v195
  s_waitcnt vmcnt(2)
  v_max3_u32 v6, v6, v196, v197
  v_max3_u32 v6, v6, v198, v199
  s_waitcnt vmcnt(1)
  v_max3_u32 v6, v6, v200, v201
  v_max3_u32 v6, v6, v202, v203
  s_waitcnt vmcnt(0)
  v_max3_u32 v6, v6, v204, v205
  v_max3_u32 v6, v6, v206, v207
  v_cmp_eq_u32 vcc, -1, v6
  s_cbranch_vccz poe_71
  s_sub_u32 s15, s15, 1
  s_cbranch_scc0 po_70
  s_mov_b32 s15, 0
poe_71:
  v_pk_add_f32 v[176:177], v[176:177], v[192:193]
  v_pk_add_f32 v[178:179], v[178:179], v[194:195]
  v_pk_add_f32 v[180:181], v[180:181], v[196:197]
  v_pk_add_f32 v[182:183], v[182:183], v[198:199]
  v_pk_add_f32 v[184:185], v[184:185], v[200:201]
  v_pk_add_f32 v[186:187], v[186:187], v[202:203]
  v_pk_add_f32 v[188:189], v[188:189], v[204:205]
  v_pk_add_f32 v[190:191], v[190:191], v[206:207]
  v_pk_add_f32 v[176:177], v[176:177], v[184:185]
  v_pk_add_f32 v[178:179], v[178:179], v[186:187]
  v_pk_add_f32 v[180:181], v[180:181], v[188:189]
  v_pk_add_f32 v[182:183], v[182:183], v[190:191]
  v_pk_add_f32 v[176:177], v[176:177], v[180:181]
  v_pk_add_f32 v[178:179], v[178:179], v[182:183]
  v_pk_fma_f32 v[176:177], v[176:177], v[232:233], v[228:229]
  v_pk_fma_f32 v[178:179], v[178:179], v[234:235], v[230:231]
  v_cvt_pk_bf16_f32 v114, v176, v177
  v_cvt_pk_bf16_f32 v115, v178, v179
  v_lshlrev_b32 v176, 16, v114
  v_and_b32 v177, 0xffff0000, v114
  v_lshlrev_b32 v178, 16, v115
  v_and_b32 v179, 0xffff0000, v115
  v_readfirstlane_b32 s58, v176
  s_nop 1
  v_pk_add_f32 v[180:181], v[176:177], s[58:59] op_sel_hi:[1,0] neg_lo:[0,1] neg_hi:[0,1]
  v_pk_add_f32 v[182:183], v[178:179], s[58:59] op_sel_hi:[1,0] neg_lo:[0,1] neg_hi:[0,1]
  v_pk_add_f32 v[184:185], v[180:181], v[182:183]
  v_pk_mul_f32 v[180:181], v[180:181], v[180:181]
  v_add_f32 v8, v184, v185
  v_pk_fma_f32 v[180:181], v[182:183], v[182:183], v[180:181]
  v_add_f32 v9, v180, v181
  s_mov_b64 exec, -1
  v_add_f32 v8, v8, v8 row_ror:1 row_mask:0xf bank_mask:0xf
  s_nop 0
  v_add_f32 v9, v9, v9 row_ror:1 row_mask:0xf bank_mask:0xf
  v_add_f32 v8, v8, v8 row_ror:2 row_mask:0xf bank_mask:0xf
  s_nop 0
  v_add_f32 v9, v9, v9 row_ror:2 row_mask:0xf bank_mask:0xf
  v_add_f32 v8, v8, v8 row_ror:4 row_mask:0xf bank_mask:0xf
  s_nop 0
  v_add_f32 v9, v9, v9 row_ror:4 row_mask:0xf bank_mask:0xf
  v_add_f32 v8, v8, v8 row_ror:8 row_mask:0xf bank_mask:0xf
  s_nop 0
  v_add_f32 v9, v9, v9 row_ror:8 row_mask:0xf bank_mask:0xf
  v_mov_b32 v10, v8
  v_mov_b32 v11, v9
  s_nop 0
  v_permlane16_swap_b32 v8, v10
  v_permlane16_swap_b32 v9, v11
  v_add_f32 v8, v8, v10
  v_add_f32 v9, v9, v11
  v_mov_b32 v10, v8
  v_mov_b32 v11, v9
  s_nop 0
  v_permlane32_swap_b32 v8, v10
  v_permlane32_swap_b32 v9, v11
  v_add_f32 v8, v8, v10
  v_add_f32 v9, v9, v11
  v_mul_f32 v10, 0x3baaaaab, v8
  v_fma_f32 v9, -v10, v8, v9
  v_add_f32 v8, s58, v10
  s_mov_b64 exec, 1
  ds_write_b64 v112, v[8:9]
  s_mov_b64 exec, s[10:11]
  s_cmp_lg_u32 s56, s4
  s_cbranch_scc1 L_tO_nx
  buffer_store_dwordx2 v[114:115], v251, s[48:51], s99 offen sc1
L_tO_nx:
  s_waitcnt lgkmcnt(0)
  s_cmp_eq_u32 s1, 0
  s_cbranch_scc1 hb_72
  s_barrier
hb_72:
  ds_read_b128 v[212:215], v113
  ds_read_b64 v[216:217], v113 offset:16
  s_waitcnt lgkmcnt(0)
  v_pk_add_f32 v[8:9], v[212:213], v[214:215]
  v_pk_add_f32 v[8:9], v[8:9], v[216:217]
  v_mul_f32 v8, 0x3eaaaaab, v8
  v_mul_f32 v9, 0x3ae38e39, v9
  v_sub_f32 v212, v212, v8
  v_sub_f32 v214, v214, v8
  v_sub_f32 v216, v216, v8
  v_cvt_pk_bf16_f32 v8, v8, v8
  v_mul_f32 v10, v212, v212
  v_lshlrev_b32 v8, 16, v8
  v_pk_add_f32 v[176:177], v[176:177], v[8:9] op_sel_hi:[1,0] neg_lo:[0,1] neg_hi:[0,1]
  v_fmac_f32 v10, v214, v214
  v_pk_add_f32 v[178:179], v[178:179], v[8:9] op_sel_hi:[1,0] neg_lo:[0,1] neg_hi:[0,1]
  v_fmac_f32 v10, v216, v216
  v_pk_mul_f32 v[176:177], v[176:177], v[240:241]
  v_fmac_f32 v9, 0x3eaaaaab, v10
  v_pk_mul_f32 v[178:179], v[178:179], v[242:243]
  v_max_f32 v9, 0, v9
  v_add_f32 v9, 0x3727c5ac, v9
  v_rsq_f32 v8, v9
  s_nop 0
  v_pk_fma_f32 v[176:177], v[176:177], v[8:9], v[236:237] op_sel_hi:[1,0,1]
  v_pk_fma_f32 v[178:179], v[178:179], v[8:9], v[238:239] op_sel_hi:[1,0,1]
  v_cvt_pk_bf16_f32 v6, v176, v177
  v_cvt_pk_bf16_f32 v7, v178, v179
  s_cmp_eq_u32 s100, 1
  s_cbranch_scc0 st_73_g
  buffer_store_dwordx2 v[6:7], v116, s[48:51], s98 offen
  s_branch st_73
st_73_g:
  buffer_store_dwordx2 v[6:7], v116, s[48:51], s98 offen sc1
st_73:
  s_mov_b64 exec, -1
  s_branch L_fin
L_tH:
  s_cmp_ge_u32 s5, 13
  s_cbranch_scc1 L_tD
L_tY:
  s_branch L_fin
L_tD:
  s_mov_b32 s44, s32
  s_mov_b32 s45, s33
  s_mov_b32 s46, 5308416
  s_mov_b32 s47, 0x20000
  s_mul_i32 s6, s4, 663552
  s_sub_u32 s8, s5, 13
  s_lshl_b32 s8, s8, 7
  s_add_u32 s6, s6, s8
  s_movk_i32 s7, 1152
  s_mul_i32 s8, s9, 160
  s_min_u32 s8, s8, 448
  s_mul_i32 s8, s8, s7
  s_add_u32 s6, s6, s8
  s_lshl_b32 s8, s7, 3
  v_mul_lo_u32 v3, v1, s8
  v_lshl_add_u32 v3, v2, 3, v3
  v_mul_u32_u24 v3, 2304, v1
  v_lshl_add_u32 v3, v2, 3, v3
  s_and_b32 s46, s46, s1
  v_lshrrev_b32 v3, 3, v0
  v_mul_u32_u24 v3, 1152, v3
  v_and_b32 v4, 7, v0
  v_lshl_add_u32 v3, v4, 4, v3
  s_mul_i32 s7, s9, 20480
  v_lshlrev_b32 v4, 8, v1
  v_lshl_add_u32 v4, v2, 3, v4
  v_add_u32 v4, s7, v4
  s_sub_u32 s97, s96, 24
  s_and_b32 s97, s97, s1
  s_mov_b32 s58, 3384094
sp_74:
  ds_read_b32 v11, v10
  s_waitcnt lgkmcnt(0)
  v_readfirstlane_b32 s8, v11
  s_cmp_ge_u32 s8, s97
  s_cbranch_scc1 sp_74_ok
  s_sleep 64
  s_sub_u32 s58, s58, 1
  s_cbranch_scc0 sp_74
sp_74_ok:
  s_sub_u32 s97, s96, 0
  s_and_b32 s97, s97, s1
  s_mov_b32 s58, 60606060
sp_75:
  ds_read_b32 v11, v10
  s_waitcnt lgkmcnt(0)
  v_readfirstlane_b32 s8, v11
  s_cmp_ge_u32 s8, s97
  s_cbranch_scc1 sp_75_ok
  s_sleep 2
  s_sub_u32 s58, s58, 1
  s_cbranch_scc0 sp_75
sp_75_ok:
  v_mov_b32 v12, 147508
  s_and_b32 s97, s1, 1
  s_mov_b32 s58, 83333333
sp_76:
  ds_read_b32 v11, v12
  s_waitcnt lgkmcnt(0)
  v_readfirstlane_b32 s8, v11
  s_cmp_ge_u32 s8, s97
  s_cbranch_scc1 sp_76_ok
  s_sleep 1
  s_sub_u32 s58, s58, 1
  s_cbranch_scc0 sp_76
sp_76_ok:
  s_cmp_eq_u32 s1, 0
  s_cbranch_scc1 L_tD_ld
  s_add_u32 m0, s7, 0
  s_add_u32 s8, s6, 0
  buffer_load_dwordx4 v3, s[44:47], s8 offen nt lds
  s_add_u32 m0, s7, 1024
  s_add_u32 s8, s6, 9216
  buffer_load_dwordx4 v3, s[44:47], s8 offen nt lds
  s_add_u32 m0, s7, 2048
  s_add_u32 s8, s6, 18432
  buffer_load_dwordx4 v3, s[44:47], s8 offen nt lds
  s_add_u32 m0, s7, 3072
  s_add_u32 s8, s6, 27648
  buffer_load_dwordx4 v3, s[44:47], s8 offen nt lds
  s_add_u32 m0, s7, 4096
  s_add_u32 s8, s6, 36864
  buffer_load_dwordx4 v3, s[44:47], s8 offen nt lds
  s_add_u32 m0, s7, 5120
  s_add_u32 s8, s6, 46080
  buffer_load_dwordx4 v3, s[44:47], s8 offen nt lds
  s_add_u32 m0, s7, 6144
  s_add_u32 s8, s6, 55296
  buffer_load_dwordx4 v3, s[44:47], s8 offen nt lds
  s_add_u32 m0, s7, 7168
  s_add_u32 s8, s6, 64512
  buffer_load_dwordx4 v3, s[44:47], s8 offen nt lds
  s_add_u32 m0, s7, 8192
  s_add_u32 s8, s6, 73728
  buffer_load_dwordx4 v3, s[44:47], s8 offen nt lds
  s_add_u32 m0, s7, 9216
  s_add_u32 s8, s6, 82944
  buffer_load_dwordx4 v3, s[44:47], s8 offen nt lds
  s_add_u32 m0, s7, 10240
  s_add_u32 s8, s6, 92160
  buffer_load_dwordx4 v3, s[44:47], s8 offen nt lds
  s_add_u32 m0, s7, 11264
  s_add_u32 s8, s6, 101376
  buffer_load_dwordx4 v3, s[44:47], s8 offen nt lds
  s_waitcnt vmcnt(11)
  s_add_u32 m0, s7, 12288
  s_add_u32 s8, s6, 110592
  buffer_load_dwordx4 v3, s[44:47], s8 offen nt lds
  s_waitcnt vmcnt(11)
  s_add_u32 m0, s7, 13312
  s_add_u32 s8, s6, 119808
  buffer_load_dwordx4 v3, s[44:47], s8 offen nt lds
  s_waitcnt vmcnt(11)
  s_add_u32 m0, s7, 14336
  s_add_u32 s8, s6, 129024
  buffer_load_dwordx4 v3, s[44:47], s8 offen nt lds
  s_waitcnt vmcnt(11)
  s_add_u32 m0, s7, 15360
  s_add_u32 s8, s6, 138240
  buffer_load_dwordx4 v3, s[44:47], s8 offen nt lds
  s_cmp_ge_u32 s9, 2
  s_cselect_b32 s46, 0, s46
  s_waitcnt vmcnt(11)
  s_add_u32 m0, s7, 16384
  s_add_u32 s8, s6, 147456
  buffer_load_dwordx4 v3, s[44:47], s8 offen nt lds
  s_waitcnt vmcnt(11)
  s_add_u32 m0, s7, 17408
  s_add_u32 s8, s6, 156672
  buffer_load_dwordx4 v3, s[44:47], s8 offen nt lds
  s_waitcnt vmcnt(11)
  s_add_u32 m0, s7, 18432
  s_add_u32 s8, s6, 165888
  buffer_load_dwordx4 v3, s[44:47], s8 offen nt lds
  s_waitcnt vmcnt(11)
  s_add_u32 m0, s7, 19456
  s_add_u32 s8, s6, 175104
  buffer_load_dwordx4 v3, s[44:47], s8 offen nt lds
L_tD_ld:
  s_waitcnt vmcnt(16) lgkmcnt(6)
  ds_read_b64 v[32:33], v4 offset:0
  ds_read_b64 v[34:35], v4 offset:1024
  ds_read_b64 v[36:37], v4 offset:2048
  ds_read_b64 v[38:39], v4 offset:3072
  ds_read_b64 v[40:41], v4 offset:128
  ds_read_b64 v[42:43], v4 offset:1152
  ds_read_b64 v[44:45], v4 offset:2176
  ds_read_b64 v[46:47], v4 offset:3200
  s_waitcnt vmcnt(12) lgkmcnt(6)
  ds_read_b64 v[48:49], v4 offset:4096
  ds_read_b64 v[50:51], v4 offset:5120
  ds_read_b64 v[52:53], v4 offset:6144
  ds_read_b64 v[54:55], v4 offset:7168
  ds_read_b64 v[56:57], v4 offset:4224
  ds_read_b64 v[58:59], v4 offset:5248
  ds_read_b64 v[60:61], v4 offset:6272
  ds_read_b64 v[62:63], v4 offset:7296
  s_waitcnt lgkmcnt(8)
  v_perm_b32 v16, v34, v32, s60
  v_perm_b32 v17, v38, v36, s60
  v_perm_b32 v18, v42, v40, s60
  v_perm_b32 v19, v46, v44, s60
  v_perm_b32 v20, v34, v32, s61
  v_perm_b32 v21, v38, v36, s61
  v_perm_b32 v22, v42, v40, s61
  v_perm_b32 v23, v46, v44, s61
  v_perm_b32 v24, v35, v33, s60
  v_perm_b32 v25, v39, v37, s60
  v_perm_b32 v26, v43, v41, s60
  v_perm_b32 v27, v47, v45, s60
  v_perm_b32 v28, v35, v33, s61
  v_perm_b32 v29, v39, v37, s61
  v_perm_b32 v30, v43, v41, s61
  v_perm_b32 v31, v47, v45, s61
  s_waitcnt vmcnt(8) lgkmcnt(6)
  ds_read_b64 v[64:65], v4 offset:8192
  ds_read_b64 v[66:67], v4 offset:9216
  ds_read_b64 v[68:69], v4 offset:10240
  ds_read_b64 v[70:71], v4 offset:11264
  ds_read_b64 v[72:73], v4 offset:8320
  ds_read_b64 v[74:75], v4 offset:9344
  ds_read_b64 v[76:77], v4 offset:10368
  ds_read_b64 v[78:79], v4 offset:11392
  s_waitcnt lgkmcnt(8)
  v_perm_b32 v32, v50, v48, s60
  v_perm_b32 v33, v54, v52, s60
  v_perm_b32 v34, v58, v56, s60
  v_perm_b32 v35, v62, v60, s60
  v_perm_b32 v36, v50, v48, s61
  v_perm_b32 v37, v54, v52, s61
  v_perm_b32 v38, v58, v56, s61
  v_perm_b32 v39, v62, v60, s61
  v_perm_b32 v40, v51, v49, s60
  v_perm_b32 v41, v55, v53, s60
  v_perm_b32 v42, v59, v57, s60
  v_perm_b32 v43, v63, v61, s60
  v_perm_b32 v44, v51, v49, s61
  v_perm_b32 v45, v55, v53, s61
  v_perm_b32 v46, v59, v57, s61
  v_perm_b32 v47, v63, v61, s61
  s_waitcnt vmcnt(4) lgkmcnt(6)
  ds_read_b64 v[80:81], v4 offset:12288
  ds_read_b64 v[82:83], v4 offset:13312
  ds_read_b64 v[84:85], v4 offset:14336
  ds_read_b64 v[86:87], v4 offset:15360
  ds_read_b64 v[88:89], v4 offset:12416
  ds_read_b64 v[90:91], v4 offset:13440
  ds_read_b64 v[92:93], v4 offset:14464
  ds_read_b64 v[94:95], v4 offset:15488
  s_waitcnt lgkmcnt(8)
  v_perm_b32 v48, v66, v64, s60
  v_perm_b32 v49, v70, v68, s60
  v_perm_b32 v50, v74, v72, s60
  v_perm_b32 v51, v78, v76, s60
  v_perm_b32 v52, v66, v64, s61
  v_perm_b32 v53, v70, v68, s61
  v_perm_b32 v54, v74, v72, s61
  v_perm_b32 v55, v78, v76, s61
  v_perm_b32 v56, v67, v65, s60
  v_perm_b32 v57, v71, v69, s60
  v_perm_b32 v58, v75, v73, s60
  v_perm_b32 v59, v79, v77, s60
  v_perm_b32 v60, v67, v65, s61
  v_perm_b32 v61, v71, v69, s61
  v_perm_b32 v62, v75, v73, s61
  v_perm_b32 v63, v79, v77, s61
  s_waitcnt vmcnt(0) lgkmcnt(6)
  ds_read_b64 v[96:97], v4 offset:16384
  ds_read_b64 v[98:99], v4 offset:17408
  ds_read_b64 v[100:101], v4 offset:18432
  ds_read_b64 v[102:103], v4 offset:19456
  ds_read_b64 v[104:105], v4 offset:16512
  ds_read_b64 v[106:107], v4 offset:17536
  ds_read_b64 v[108:109], v4 offset:18560
  ds_read_b64 v[110:111], v4 offset:19584
  s_waitcnt lgkmcnt(8)
  v_perm_b32 v64, v82, v80, s60
  v_perm_b32 v65, v86, v84, s60
  v_perm_b32 v66, v90, v88, s60
  v_perm_b32 v67, v94, v92, s60
  v_perm_b32 v68, v82, v80, s61
  v_perm_b32 v69, v86, v84, s61
  v_perm_b32 v70, v90, v88, s61
  v_perm_b32 v71, v94, v92, s61
  v_perm_b32 v72, v83, v81, s60
  v_perm_b32 v73, v87, v85, s60
  v_perm_b32 v74, v91, v89, s60
  v_perm_b32 v75, v95, v93, s60
  v_perm_b32 v76, v83, v81, s61
  v_perm_b32 v77, v87, v85, s61
  v_perm_b32 v78, v91, v89, s61
  v_perm_b32 v79, v95, v93, s61
  s_waitcnt lgkmcnt(0)
  v_perm_b32 v80, v98, v96, s60
  v_perm_b32 v81, v102, v100, s60
  v_perm_b32 v82, v106, v104, s60
  v_perm_b32 v83, v110, v108, s60
  v_perm_b32 v84, v98, v96, s61
  v_perm_b32 v85, v102, v100, s61
  v_perm_b32 v86, v106, v104, s61
  v_perm_b32 v87, v110, v108, s61
  v_perm_b32 v88, v99, v97, s60
  v_perm_b32 v89, v103, v101, s60
  v_perm_b32 v90, v107, v105, s60
  v_perm_b32 v91, v111, v109, s60
  v_perm_b32 v92, v99, v97, s61
  v_perm_b32 v93, v103, v101, s61
  v_perm_b32 v94, v107, v105, s61
  v_perm_b32 v95, v111, v109, s61
  s_mov_b32 s44, s38
  s_mov_b32 s45, s39
  s_mov_b32 s46, 9216
  s_mov_b32 s47, 0x20000
  s_and_b32 s46, s46, s1
  s_mul_i32 s6, s4, 9216
  s_add_u32 s6, s6, 386048
  s_mul_i32 s8, s9, 2560
  s_min_u32 s8, s8, 7168
  s_add_u32 s6, s6, s8
  s_cmp_ge_u32 s9, 2
  s_cselect_b32 s8, 0, 2048
  s_add_u32 s7, s6, s8
  v_lshrrev_b32 v5, 5, v0
  v_mul_u32_u24 v5, 9, v5
  s_mul_i32 s8, s9, 18
  s_add_u32 s8, s8, s5
  s_sub_u32 s8, s8, 13
  v_add_u32 v5, s8, v5
  v_lshrrev_b32 v6, 2, v5
  v_and_b32 v5, 3, v5
  v_lshlrev_b32 v5, 11, v5
  v_lshl_add_u32 v5, v6, 14, v5
  v_and_b32 v6, 31, v0
  v_lshl_add_u32 v253, v6, 3, v5
  s_lshl_b32 s57, s4, 8
  s_add_u32 s57, s57, 770048
  s_add_u32 s3, s57, 8192
  s_cmp_lg_u32 s9, 3
  s_cbranch_scc1 L_tD2
  s_add_u32 s98, s59, 376832
po_77:
  buffer_load_dword v247, v245, s[48:51], s98 offen sc1
  s_waitcnt vmcnt(0)
  v_mov_b32 v6, v247
  v_cmp_eq_u32 vcc, -1, v6
  s_cbranch_vccz poe_78
  s_sub_u32 s15, s15, 1
  s_cbranch_scc0 po_77
  s_mov_b32 s15, 0
poe_78:
  v_and_b32 v5, 1, v1
  v_cmp_eq_u32 vcc, 1, v5
  v_lshlrev_b32 v5, 16, v247
  v_and_b32 v247, 0xffff0000, v247
  v_cndmask_b32 v247, v5, v247, vcc
L_tD2:
po_79:
  buffer_load_dwordx4 v[176:179], v250, s[48:51], s6 offen offset:0 sc1
  buffer_load_dwordx4 v[184:187], v250, s[48:51], s6 offen offset:1024 sc1
  buffer_load_dwordx4 v[192:195], v249, s[48:51], s7 offen sc1
  s_waitcnt vmcnt(2)
  v_max3_u32 v6, v176, v177, v178
  v_max_u32 v6, v6, v179
  s_waitcnt vmcnt(1)
  v_max3_u32 v6, v6, v184, v185
  v_max3_u32 v6, v6, v186, v187
  s_waitcnt vmcnt(0)
  v_max3_u32 v6, v6, v192, v193
  v_max3_u32 v6, v6, v194, v195
  v_cmp_eq_u32 vcc, -1, v6
  s_cbranch_vccz poe_80
  s_sub_u32 s15, s15, 1
  s_cbranch_scc0 po_79
  s_mov_b32 s15, 0
poe_80:
  v_mov_b32 v180, v176 row_ror:8 row_mask:0xf bank_mask:0xf
  v_mov_b32 v181, v177 row_ror:8 row_mask:0xf bank_mask:0xf
  v_mov_b32 v182, v178 row_ror:8 row_mask:0xf bank_mask:0xf
  v_mov_b32 v183, v179 row_ror:8 row_mask:0xf bank_mask:0xf
  v_mfma_f32_16x16x32_bf16 v[212:215], v[16:19], v[176:179], 0
  v_mfma_f32_16x16x32_bf16 v[216:219], v[20:23], v[176:179], 0
  v_mfma_f32_16x16x32_bf16 v[220:223], v[24:27], v[176:179], 0
  v_mfma_f32_16x16x32_bf16 v[224:227], v[28:31], v[176:179], 0
  v_mfma_f32_16x16x32_bf16 v[212:215], v[32:35], v[180:183], v[212:215]
  v_mfma_f32_16x16x32_bf16 v[216:219], v[36:39], v[180:183], v[216:219]
  v_mfma_f32_16x16x32_bf16 v[220:223], v[40:43], v[180:183], v[220:223]
  v_mfma_f32_16x16x32_bf16 v[224:227], v[44:47], v[180:183], v[224:227]
  v_mov_b32 v188, v184 row_ror:8 row_mask:0xf bank_mask:0xf
  v_mov_b32 v189, v185 row_ror:8 row_mask:0xf bank_mask:0xf
  v_mov_b32 v190, v186 row_ror:8 row_mask:0xf bank_mask:0xf
  v_mov_b32 v191, v187 row_ror:8 row_mask:0xf bank_mask:0xf
  v_mfma_f32_16x16x32_bf16 v[212:215], v[48:51], v[184:187], v[212:215]
  v_mfma_f32_16x16x32_bf16 v[216:219], v[52:55], v[184:187], v[216:219]
  v_mfma_f32_16x16x32_bf16 v[220:223], v[56:59], v[184:187], v[220:223]
  v_mfma_f32_16x16x32_bf16 v[224:227], v[60:63], v[184:187], v[224:227]
  v_mfma_f32_16x16x32_bf16 v[212:215], v[64:67], v[188:191], v[212:215]
  v_mfma_f32_16x16x32_bf16 v[216:219], v[68:71], v[188:191], v[216:219]
  v_mfma_f32_16x16x32_bf16 v[220:223], v[72:75], v[188:191], v[220:223]
  v_mfma_f32_16x16x32_bf16 v[224:227], v[76:79], v[188:191], v[224:227]
  v_mfma_f32_16x16x32_bf16 v[212:215], v[80:83], v[192:195], v[212:215]
  v_mfma_f32_16x16x32_bf16 v[216:219], v[84:87], v[192:195], v[216:219]
  v_mfma_f32_16x16x32_bf16 v[220:223], v[88:91], v[192:195], v[220:223]
  v_mfma_f32_16x16x32_bf16 v[224:227], v[92:95], v[192:195], v[224:227]
  s_nop 4
  s_mov_b32 s10, 0x00ff00ff
  s_mov_b32 s11, 0x00ff00ff
  s_mov_b64 exec, s[10:11]
  ds_write_b128 v13, v[212:215] offset:0
  ds_write_b128 v13, v[216:219] offset:16
  ds_write_b128 v13, v[220:223] offset:32
  ds_write_b128 v13, v[224:227] offset:48
  s_mov_b64 exec, -1
  s_waitcnt lgkmcnt(0)
  s_cmp_eq_u32 s1, 0
  s_cbranch_scc1 hb_81
  s_barrier
hb_81:
  ds_read_b32 v212, v15 offset:0
  ds_read_b32 v213, v15 offset:16
  ds_read_b32 v214, v15 offset:2176
  ds_read_b32 v215, v15 offset:2192
  ds_read_b32 v216, v15 offset:4352
  ds_read_b32 v217, v15 offset:4368
  ds_read_b32 v218, v15 offset:6528
  ds_read_b32 v219, v15 offset:6544
  s_waitcnt lgkmcnt(4)
  v_add_f32 v212, v212, v214
  v_add_f32 v213, v213, v215
  s_waitcnt lgkmcnt(0)
  v_add_f32 v216, v216, v218
  v_add_f32 v217, v217, v219
  v_add_f32 v10, v212, v216
  v_add_f32 v11, v213, v217
  buffer_store_dwordx2 v[10:11], v253, s[48:51], s57 offen sc1
  buffer_store_dwordx2 v[10:11], v253, s[48:51], s3 offen sc1
  s_cmp_lg_u32 s9, 3
  s_cbranch_scc1 L_fin
  s_waitcnt vmcnt(0)
po_82:
  buffer_load_dwordx4 v[176:179], v248, s[48:51], s13 offen offset:0 sc1
  buffer_load_dwordx4 v[180:183], v248, s[48:51], s13 offen offset:1024 sc1
  s_waitcnt vmcnt(1)
  v_max3_u32 v6, v176, v177, v178
  v_max_u32 v6, v6, v179
  s_waitcnt vmcnt(0)
  v_max3_u32 v6, v6, v180, v181
  v_max3_u32 v6, v6, v182, v183
  v_cmp_eq_u32 vcc, -1, v6
  s_cbranch_vccz poe_83
  s_sub_u32 s15, s15, 1
  s_cbranch_scc0 po_82
  s_mov_b32 s15, 0
poe_83:
  v_add_f32 v176, v176, v180
  v_add_f32 v177, v177, v181
  v_add_f32 v178, v178, v182
  v_add_f32 v179, v179, v183
  s_nop 0
  v_permlane32_swap_b32 v176, v178
  v_permlane32_swap_b32 v177, v179
  v_add_f32 v176, v176, v178
  v_add_f32 v177, v177, v179
  s_nop 1
  v_permlane16_swap_b32 v176, v177
  v_add_f32 v8, v176, v177
  v_fma_f32 v8, v8, v244, v247
  v_cvt_pk_bf16_f32 v8, v8, v8
  buffer_store_short v8, v246, s[44:47], s59 offen
  s_cmp_eq_u32 s1, 0
  s_cbranch_scc1 L_fin
  s_endpgm
L_tF:
  s_lshl_b32 s8, s9, 2
  s_min_u32 s6, s9, 1
  s_add_u32 s8, s8, s6
  s_add_u32 s8, s8, 2
  s_mul_i32 s6, s8, 294912
  s_mul_i32 s7, s4, 1152
  s_add_u32 s6, s6, s7
  s_lshl_b32 s7, s5, 7
  s_add_u32 s6, s6, s7
  v_and_b32 v5, 7, v0
  v_mul_u32_u24 v3, 73728, v1
  v_lshl_add_u32 v3, v5, 4, v3
  v_add_u32 v3, s6, v3
  v_and_b32 v5, 8, v0
  v_cmp_eq_u32 vcc, 0, v5
  v_mov_b32 v4, s30
  v_mov_b32 v5, s31
  v_mov_b32 v6, s28
  v_mov_b32 v7, s29
  v_cndmask_b32 v4, v4, v6, vcc
  v_cndmask_b32 v5, v5, v7, vcc
  v_add_co_u32 v4, vcc, v4, v3
  s_mov_b32 s44, 9216
  s_mov_b32 s45, 0
  v_addc_co_u32 v5, vcc, 0, v5, vcc
  s_mov_b32 s46, 230400
  s_mov_b32 s47, 0
  v_mov_b32 v192, 0
  v_mov_b32 v193, 0
  v_mov_b32 v194, 0
  v_mov_b32 v195, 0
  v_mov_b32 v196, 0
  v_mov_b32 v197, 0
  v_mov_b32 v198, 0
  v_mov_b32 v199, 0
  v_mov_b32 v200, 0
  v_mov_b32 v201, 0
  v_mov_b32 v202, 0
  v_mov_b32 v203, 0
  v_mov_b32 v204, 0
  v_mov_b32 v205, 0
  v_mov_b32 v206, 0
  v_mov_b32 v207, 0
  v_mov_b32 v208, 0
  v_mov_b32 v209, 0
  v_mov_b32 v210, 0
  v_mov_b32 v211, 0
  v_mov_b32 v212, 0
  v_mov_b32 v213, 0
  v_mov_b32 v214, 0
  v_mov_b32 v215, 0
  v_mov_b32 v216, 0
  v_mov_b32 v217, 0
  v_mov_b32 v218, 0
  v_mov_b32 v219, 0
  v_mov_b32 v220, 0
  v_mov_b32 v221, 0
  v_mov_b32 v222, 0
  v_mov_b32 v223, 0
  s_mul_i32 s6, s4, 9216
  s_add_u32 s6, s6, 303104
  s_lshl_b32 s8, s9, 2
  s_min_u32 s7, s9, 1
  s_add_u32 s8, s8, s7
  s_lshl_b32 s8, s8, 9
  s_add_u32 s6, s6, s8
  s_add_u32 s7, s6, 2048
  s_mul_i32 s57, s4, 9216
  s_lshl_b32 s8, s5, 10
  s_add_u32 s57, s57, s8
  s_lshl_b32 s8, s9, 5
  s_add_u32 s57, s57, s8
  s_add_u32 s57, s57, 386048
  v_bfe_u32 v7, v0, 2, 3
  v_lshlrev_b32 v7, 7, v7
  v_lshrrev_b32 v8, 5, v0
  v_lshl_add_u32 v7, v8, 4, v7
  v_and_b32 v9, 3, v0
  v_lshl_add_u32 v7, v9, 2, v7
  s_mul_i32 s8, s9, 4224
  v_and_b32 v9, 7, v0
  v_mul_u32_u24 v228, 528, v9
  v_lshl_add_u32 v228, v1, 7, v228
  v_and_b32 v9, 8, v0
  v_lshl_add_u32 v228, v9, 3, v228
  v_add_u32 v228, s8, v228
  v_mul_u32_u24 v8, 528, v8
  v_and_b32 v9, 31, v0
  v_lshl_add_u32 v8, v9, 3, v8
  s_mul_i32 s8, s9, 1056
  v_add_u32 v229, s8, v8
  s_mov_b32 s10, s1
  s_mov_b32 s11, s1
  s_sub_u32 s97, s96, 24
  s_and_b32 s97, s97, s1
  s_mov_b32 s58, 3384094
sp_84:
  ds_read_b32 v11, v10
  s_waitcnt lgkmcnt(0)
  v_readfirstlane_b32 s8, v11
  s_cmp_ge_u32 s8, s97
  s_cbranch_scc1 sp_84_ok
  s_sleep 64
  s_sub_u32 s58, s58, 1
  s_cbranch_scc0 sp_84
sp_84_ok:
  s_sub_u32 s97, s96, 0
  s_and_b32 s97, s97, s1
  s_mov_b32 s58, 60606060
sp_85:
  ds_read_b32 v11, v10
  s_waitcnt lgkmcnt(0)
  v_readfirstlane_b32 s8, v11
  s_cmp_ge_u32 s8, s97
  s_cbranch_scc1 sp_85_ok
  s_sleep 2
  s_sub_u32 s58, s58, 1
  s_cbranch_scc0 sp_85
sp_85_ok:
  s_cmp_eq_u32 s1, 0
  s_cbranch_scc1 L_tF_5
  global_load_dwordx4 v[112:115], v[4:5], off nt
  v_lshl_add_u64 v[4:5], v[4:5], 0, s[44:45]
  global_load_dwordx4 v[116:119], v[4:5], off nt
  v_lshl_add_u64 v[4:5], v[4:5], 0, s[44:45]
  global_load_dwordx4 v[120:123], v[4:5], off nt
  v_lshl_add_u64 v[4:5], v[4:5], 0, s[44:45]
  global_load_dwordx4 v[124:127], v[4:5], off nt
  v_lshl_add_u64 v[4:5], v[4:5], 0, s[44:45]
  global_load_dwordx4 v[128:131], v[4:5], off nt
  v_lshl_add_u64 v[4:5], v[4:5], 0, s[44:45]
  global_load_dwordx4 v[132:135], v[4:5], off nt
  v_lshl_add_u64 v[4:5], v[4:5], 0, s[44:45]
  global_load_dwordx4 v[136:139], v[4:5], off nt
  v_lshl_add_u64 v[4:5], v[4:5], 0, s[44:45]
  s_waitcnt vmcnt(6)
  global_load_dwordx4 v[140:143], v[4:5], off nt
  v_lshl_add_u64 v[4:5], v[4:5], 0, s[46:47]
  s_waitcnt vmcnt(6)
  global_load_dwordx4 v[144:147], v[4:5], off nt
  v_lshl_add_u64 v[4:5], v[4:5], 0, s[44:45]
  s_waitcnt vmcnt(6)
  global_load_dwordx4 v[148:151], v[4:5], off nt
  v_lshl_add_u64 v[4:5], v[4:5], 0, s[44:45]
  s_waitcnt vmcnt(6)
  global_load_dwordx4 v[152:155], v[4:5], off nt
  v_lshl_add_u64 v[4:5], v[4:5], 0, s[44:45]
  s_waitcnt vmcnt(6)
  global_load_dwordx4 v[156:159], v[4:5], off nt
  v_lshl_add_u64 v[4:5], v[4:5], 0, s[44:45]
  s_waitcnt vmcnt(6)
  global_load_dwordx4 v[160:163], v[4:5], off nt
  v_lshl_add_u64 v[4:5], v[4:5], 0, s[44:45]
  s_waitcnt vmcnt(6)
  global_load_dwordx4 v[164:167], v[4:5], off nt
  v_lshl_add_u64 v[4:5], v[4:5], 0, s[44:45]
  s_waitcnt vmcnt(6)
  global_load_dwordx4 v[168:171], v[4:5], off nt
  v_perm_b32 v80, v116, v112, s60
  v_perm_b32 v81, v124, v120, s60
  v_perm_b32 v82, v132, v128, s60
  v_perm_b32 v83, v140, v136, s60
  v_lshl_add_u64 v[4:5], v[4:5], 0, s[44:45]
  s_waitcnt vmcnt(6)
  global_load_dwordx4 v[172:175], v[4:5], off nt
  v_perm_b32 v84, v116, v112, s61
  v_perm_b32 v85, v124, v120, s61
  v_perm_b32 v86, v132, v128, s61
  v_perm_b32 v87, v140, v136, s61
  v_lshl_add_u64 v[4:5], v[4:5], 0, s[46:47]
  s_waitcnt vmcnt(6)
  global_load_dwordx4 v[176:179], v[4:5], off nt
  v_perm_b32 v88, v117, v113, s60
  v_perm_b32 v89, v125, v121, s60
  v_perm_b32 v90, v133, v129, s60
  v_perm_b32 v91, v141, v137, s60
  v_lshl_add_u64 v[4:5], v[4:5], 0, s[44:45]
  s_waitcnt vmcnt(6)
  global_load_dwordx4 v[180:183], v[4:5], off nt
  v_perm_b32 v92, v117, v113, s61
  v_perm_b32 v93, v125, v121, s61
  v_perm_b32 v94, v133, v129, s61
  v_perm_b32 v95, v141, v137, s61
  v_lshl_add_u64 v[4:5], v[4:5], 0, s[44:45]
  s_waitcnt vmcnt(6)
  global_load_dwordx4 v[184:187], v[4:5], off nt
  v_perm_b32 v96, v118, v114, s60
  v_perm_b32 v97, v126, v122, s60
  v_perm_b32 v98, v134, v130, s60
  v_perm_b32 v99, v142, v138, s60
  v_lshl_add_u64 v[4:5], v[4:5], 0, s[44:45]
  s_waitcnt vmcnt(6)
  global_load_dwordx4 v[188:191], v[4:5], off nt
  v_perm_b32 v100, v118, v114, s61
  v_perm_b32 v101, v126, v122, s61
  v_perm_b32 v102, v134, v130, s61
  v_perm_b32 v103, v142, v138, s61
  v_lshl_add_u64 v[4:5], v[4:5], 0, s[44:45]
  s_waitcnt vmcnt(6)
  global_load_dwordx4 v[192:195], v[4:5], off nt
  v_perm_b32 v104, v119, v115, s60
  v_perm_b32 v105, v127, v123, s60
  v_perm_b32 v106, v135, v131, s60
  v_perm_b32 v107, v143, v139, s60
  v_lshl_add_u64 v[4:5], v[4:5], 0, s[44:45]
  s_waitcnt vmcnt(6)
  global_load_dwordx4 v[196:199], v[4:5], off nt
  v_perm_b32 v108, v119, v115, s61
  v_perm_b32 v109, v127, v123, s61
  v_perm_b32 v110, v135, v131, s61
  v_perm_b32 v111, v143, v139, s61
  v_lshl_add_u64 v[4:5], v[4:5], 0, s[44:45]
  s_waitcnt vmcnt(6)
  global_load_dwordx4 v[200:203], v[4:5], off nt
  v_perm_b32 v112, v148, v144, s60
  v_perm_b32 v113, v156, v152, s60
  v_perm_b32 v114, v164, v160, s60
  v_perm_b32 v115, v172, v168, s60
  v_lshl_add_u64 v[4:5], v[4:5], 0, s[44:45]
  s_waitcnt vmcnt(6)
  global_load_dwordx4 v[204:207], v[4:5], off nt
  v_perm_b32 v116, v148, v144, s61
  v_perm_b32 v117, v156, v152, s61
  v_perm_b32 v118, v164, v160, s61
  v_perm_b32 v119, v172, v168, s61
  v_perm_b32 v120, v149, v145, s60
  v_perm_b32 v121, v157, v153, s60
  v_perm_b32 v122, v165, v161, s60
  v_perm_b32 v123, v173, v169, s60
  v_perm_b32 v124, v149, v145, s61
  v_perm_b32 v125, v157, v153, s61
  v_perm_b32 v126, v165, v161, s61
  v_perm_b32 v127, v173, v169, s61
  v_perm_b32 v128, v150, v146, s60
  v_perm_b32 v129, v158, v154, s60
  v_perm_b32 v130, v166, v162, s60
  v_perm_b32 v131, v174, v170, s60
  v_perm_b32 v132, v150, v146, s61
  v_perm_b32 v133, v158, v154, s61
  v_perm_b32 v134, v166, v162, s61
  v_perm_b32 v135, v174, v170, s61
  v_perm_b32 v136, v151, v147, s60
  v_perm_b32 v137, v159, v155, s60
  v_perm_b32 v138, v167, v163, s60
  v_perm_b32 v139, v175, v171, s60
  v_perm_b32 v140, v151, v147, s61
  v_perm_b32 v141, v159, v155, s61
  v_perm_b32 v142, v167, v163, s61
  v_perm_b32 v143, v175, v171, s61
L_tF_5:
  s_waitcnt vmcnt(0)
  v_perm_b32 v144, v180, v176, s60
  v_perm_b32 v145, v188, v184, s60
  v_perm_b32 v146, v196, v192, s60
  v_perm_b32 v147, v204, v200, s60
  v_perm_b32 v148, v180, v176, s61
  v_perm_b32 v149, v188, v184, s61
  v_perm_b32 v150, v196, v192, s61
  v_perm_b32 v151, v204, v200, s61
  v_perm_b32 v152, v181, v177, s60
  v_perm_b32 v153, v189, v185, s60
  v_perm_b32 v154, v197, v193, s60
  v_perm_b32 v155, v205, v201, s60
  v_perm_b32 v156, v181, v177, s61
  v_perm_b32 v157, v189, v185, s61
  v_perm_b32 v158, v197, v193, s61
  v_perm_b32 v159, v205, v201, s61
  v_perm_b32 v160, v182, v178, s60
  v_perm_b32 v161, v190, v186, s60
  v_perm_b32 v162, v198, v194, s60
  v_perm_b32 v163, v206, v202, s60
  v_perm_b32 v164, v182, v178, s61
  v_perm_b32 v165, v190, v186, s61
  v_perm_b32 v166, v198, v194, s61
  v_perm_b32 v167, v206, v202, s61
  v_perm_b32 v168, v183, v179, s60
  v_perm_b32 v169, v191, v187, s60
  v_perm_b32 v170, v199, v195, s60
  v_perm_b32 v171, v207, v203, s60
  v_perm_b32 v172, v183, v179, s61
  v_perm_b32 v173, v191, v187, s61
  v_perm_b32 v174, v199, v195, s61
  v_perm_b32 v175, v207, v203, s61
  v_mov_b32 v192, 0
  v_mov_b32 v193, 0
  v_mov_b32 v194, 0
  v_mov_b32 v195, 0
  v_mov_b32 v196, 0
  v_mov_b32 v197, 0
  v_mov_b32 v198, 0
  v_mov_b32 v199, 0
  v_mov_b32 v200, 0
  v_mov_b32 v201, 0
  v_mov_b32 v202, 0
  v_mov_b32 v203, 0
  v_mov_b32 v204, 0
  v_mov_b32 v205, 0
  v_mov_b32 v206, 0
  v_mov_b32 v207, 0
L_tF_w:
po_86:
  buffer_load_dwordx4 v[236:239], v250, s[48:51], s6 offen offset:0 sc1
  buffer_load_dwordx4 v[240:243], v250, s[48:51], s6 offen offset:1024 sc1
  buffer_load_dwordx4 v[244:247], v249, s[48:51], s7 offen sc1
  s_waitcnt vmcnt(2)
  v_max3_u32 v6, v236, v237, v238
  v_max_u32 v6, v6, v239
  s_waitcnt vmcnt(1)
  v_max3_u32 v6, v6, v240, v241
  v_max3_u32 v6, v6, v242, v243
  s_waitcnt vmcnt(0)
  v_max3_u32 v6, v6, v244, v245
  v_max3_u32 v6, v6, v246, v247
  v_cmp_eq_u32 vcc, -1, v6
  s_cbranch_vccz poe_87
  s_sub_u32 s15, s15, 1
  s_cbranch_scc0 po_86
  s_mov_b32 s15, 0
poe_87:
  v_mov_b32 v192, v236 quad_perm:[0,1,2,3] row_mask:0xf bank_mask:0x3
  v_mov_b32 v193, v237 quad_perm:[0,1,2,3] row_mask:0xf bank_mask:0x3
  v_mov_b32 v194, v238 quad_perm:[0,1,2,3] row_mask:0xf bank_mask:0x3
  v_mov_b32 v195, v239 quad_perm:[0,1,2,3] row_mask:0xf bank_mask:0x3
  s_nop 0
  v_mov_b32 v196, v236 row_ror:8 row_mask:0xf bank_mask:0xc
  v_mov_b32 v197, v237 row_ror:8 row_mask:0xf bank_mask:0xc
  v_mfma_f32_16x16x32_bf16 v[176:179], v[16:19], v[192:195], 0
  v_mov_b32 v198, v238 row_ror:8 row_mask:0xf bank_mask:0xc
  v_mov_b32 v199, v239 row_ror:8 row_mask:0xf bank_mask:0xc
  v_mfma_f32_16x16x32_bf16 v[180:183], v[20:23], v[192:195], 0
  v_mfma_f32_16x16x32_bf16 v[184:187], v[24:27], v[192:195], 0
  v_mfma_f32_16x16x32_bf16 v[188:191], v[28:31], v[192:195], 0
  v_mov_b32 v200, v236 row_ror:8 row_mask:0xf bank_mask:0x3
  v_mov_b32 v201, v237 row_ror:8 row_mask:0xf bank_mask:0x3
  v_mfma_f32_16x16x32_bf16 v[176:179], v[32:35], v[196:199], v[176:179]
  v_mov_b32 v202, v238 row_ror:8 row_mask:0xf bank_mask:0x3
  v_mov_b32 v203, v239 row_ror:8 row_mask:0xf bank_mask:0x3
  v_mfma_f32_16x16x32_bf16 v[180:183], v[36:39], v[196:199], v[180:183]
  v_mfma_f32_16x16x32_bf16 v[184:187], v[40:43], v[196:199], v[184:187]
  v_mfma_f32_16x16x32_bf16 v[188:191], v[44:47], v[196:199], v[188:191]
  v_mov_b32 v204, v236 quad_perm:[0,1,2,3] row_mask:0xf bank_mask:0xc
  v_mov_b32 v205, v237 quad_perm:[0,1,2,3] row_mask:0xf bank_mask:0xc
  v_mfma_f32_16x16x32_bf16 v[176:179], v[48:51], v[200:203], v[176:179]
  v_mov_b32 v206, v238 quad_perm:[0,1,2,3] row_mask:0xf bank_mask:0xc
  v_mov_b32 v207, v239 quad_perm:[0,1,2,3] row_mask:0xf bank_mask:0xc
  v_mfma_f32_16x16x32_bf16 v[180:183], v[52:55], v[200:203], v[180:183]
  v_mfma_f32_16x16x32_bf16 v[184:187], v[56:59], v[200:203], v[184:187]
  v_mfma_f32_16x16x32_bf16 v[188:191], v[60:63], v[200:203], v[188:191]
  v_mov_b32 v208, v240 quad_perm:[0,1,2,3] row_mask:0xf bank_mask:0x3
  v_mov_b32 v209, v241 quad_perm:[0,1,2,3] row_mask:0xf bank_mask:0x3
  v_mfma_f32_16x16x32_bf16 v[176:179], v[64:67], v[204:207], v[176:179]
  v_mov_b32 v210, v242 quad_perm:[0,1,2,3] row_mask:0xf bank_mask:0x3
  v_mov_b32 v211, v243 quad_perm:[0,1,2,3] row_mask:0xf bank_mask:0x3
  v_mfma_f32_16x16x32_bf16 v[180:183], v[68:71], v[204:207], v[180:183]
  v_mfma_f32_16x16x32_bf16 v[184:187], v[72:75], v[204:207], v[184:187]
  v_mfma_f32_16x16x32_bf16 v[188:191], v[76:79], v[204:207], v[188:191]
  v_mov_b32 v212, v240 row_ror:8 row_mask:0xf bank_mask:0xc
  v_mov_b32 v213, v241 row_ror:8 row_mask:0xf bank_mask:0xc
  v_mfma_f32_16x16x32_bf16 v[176:179], v[80:83], v[208:211], v[176:179]
  v_mov_b32 v214, v242 row_ror:8 row_mask:0xf bank_mask:0xc
  v_mov_b32 v215, v243 row_ror:8 row_mask:0xf bank_mask:0xc
  v_mfma_f32_16x16x32_bf16 v[180:183], v[84:87], v[208:211], v[180:183]
  v_mfma_f32_16x16x32_bf16 v[184:187], v[88:91], v[208:211], v[184:187]
  v_mfma_f32_16x16x32_bf16 v[188:191], v[92:95], v[208:211], v[188:191]
  v_mov_b32 v216, v240 row_ror:8 row_mask:0xf bank_mask:0x3
  v_mov_b32 v217, v241 row_ror:8 row_mask:0xf bank_mask:0x3
  v_mfma_f32_16x16x32_bf16 v[176:179], v[96:99], v[212:215], v[176:179]
  v_mov_b32 v218, v242 row_ror:8 row_mask:0xf bank_mask:0x3
  v_mov_b32 v219, v243 row_ror:8 row_mask:0xf bank_mask:0x3
  v_mfma_f32_16x16x32_bf16 v[180:183], v[100:103], v[212:215], v[180:183]
  v_mfma_f32_16x16x32_bf16 v[184:187], v[104:107], v[212:215], v[184:187]
  v_mfma_f32_16x16x32_bf16 v[188:191], v[108:111], v[212:215], v[188:191]
  v_mov_b32 v220, v240 quad_perm:[0,1,2,3] row_mask:0xf bank_mask:0xc
  v_mov_b32 v221, v241 quad_perm:[0,1,2,3] row_mask:0xf bank_mask:0xc
  v_mfma_f32_16x16x32_bf16 v[176:179], v[112:115], v[216:219], v[176:179]
  v_mov_b32 v222, v242 quad_perm:[0,1,2,3] row_mask:0xf bank_mask:0xc
  v_mov_b32 v223, v243 quad_perm:[0,1,2,3] row_mask:0xf bank_mask:0xc
  v_mfma_f32_16x16x32_bf16 v[180:183], v[116:119], v[216:219], v[180:183]
  v_mfma_f32_16x16x32_bf16 v[184:187], v[120:123], v[216:219], v[184:187]
  v_mfma_f32_16x16x32_bf16 v[188:191], v[124:127], v[216:219], v[188:191]
  v_mov_b32 v192, v244 quad_perm:[0,1,2,3] row_mask:0xf bank_mask:0x3
  v_mov_b32 v193, v245 quad_perm:[0,1,2,3] row_mask:0xf bank_mask:0x3
  v_mfma_f32_16x16x32_bf16 v[176:179], v[128:131], v[220:223], v[176:179]
  v_mov_b32 v194, v246 quad_perm:[0,1,2,3] row_mask:0xf bank_mask:0x3
  v_mov_b32 v195, v247 quad_perm:[0,1,2,3] row_mask:0xf bank_mask:0x3
  v_mfma_f32_16x16x32_bf16 v[180:183], v[132:135], v[220:223], v[180:183]
  v_mfma_f32_16x16x32_bf16 v[184:187], v[136:139], v[220:223], v[184:187]
  v_mfma_f32_16x16x32_bf16 v[188:191], v[140:143], v[220:223], v[188:191]
  v_mov_b32 v196, v244 quad_perm:[0,1,2,3] row_mask:0xf bank_mask:0xc
  v_mov_b32 v197, v245 quad_perm:[0,1,2,3] row_mask:0xf bank_mask:0xc
  v_mfma_f32_16x16x32_bf16 v[176:179], v[144:147], v[192:195], v[176:179]
  v_mov_b32 v198, v246 quad_perm:[0,1,2,3] row_mask:0xf bank_mask:0xc
  v_mov_b32 v199, v247 quad_perm:[0,1,2,3] row_mask:0xf bank_mask:0xc
  v_mfma_f32_16x16x32_bf16 v[180:183], v[148:151], v[192:195], v[180:183]
  v_mfma_f32_16x16x32_bf16 v[184:187], v[152:155], v[192:195], v[184:187]
  v_mfma_f32_16x16x32_bf16 v[188:191], v[156:159], v[192:195], v[188:191]
  v_mfma_f32_16x16x32_bf16 v[176:179], v[160:163], v[196:199], v[176:179]
  v_mfma_f32_16x16x32_bf16 v[180:183], v[164:167], v[196:199], v[180:183]
  v_mfma_f32_16x16x32_bf16 v[184:187], v[168:171], v[196:199], v[184:187]
  v_mfma_f32_16x16x32_bf16 v[188:191], v[172:175], v[196:199], v[188:191]
L_tF_m:
  s_mov_b64 exec, s[10:11]
  s_nop 3
  ds_write_b128 v228, v[176:179] offset:0
  ds_write_b128 v228, v[180:183] offset:16
  ds_write_b128 v228, v[184:187] offset:32
  ds_write_b128 v228, v[188:191] offset:48
  s_mov_b64 exec, -1
  s_waitcnt lgkmcnt(0)
  s_cmp_eq_u32 s1, 0
  s_cbranch_scc1 hb_88
  s_barrier
hb_88:
  ds_read_b64 v[212:213], v229 offset:0
  ds_read_b64 v[214:215], v229 offset:256
  ds_read_b64 v[216:217], v229 offset:4224
  ds_read_b64 v[218:219], v229 offset:4480
  ds_read_b64 v[220:221], v229 offset:8448
  ds_read_b64 v[222:223], v229 offset:8704
  ds_read_b64 v[224:225], v229 offset:12672
  ds_read_b64 v[226:227], v229 offset:12928
  s_waitcnt lgkmcnt(4)
  v_pk_add_f32 v[212:213], v[212:213], v[216:217]
  v_pk_add_f32 v[214:215], v[214:215], v[218:219]
  s_waitcnt lgkmcnt(0)
  v_pk_add_f32 v[220:221], v[220:221], v[224:225]
  v_pk_add_f32 v[222:223], v[222:223], v[226:227]
  v_pk_add_f32 v[216:217], v[214:215], v[222:223]
  v_pk_add_f32 v[212:213], v[212:213], v[220:221]
  v_mul_f32 v10, v212, v212
  v_mul_f32 v11, v213, v213
  v_mul_f32 v10, 0x3d372713, v10
  v_mul_f32 v11, 0x3d372713, v11
  v_fma_f32 v10, v10, v212, v212
  v_fma_f32 v11, v11, v213, v213
  v_mul_f32 v10, 0xc0135761, v10
  v_mul_f32 v11, 0xc0135761, v11
  v_exp_f32 v10, v10
  v_exp_f32 v11, v11
  v_add_f32 v10, 1.0, v10
  v_add_f32 v11, 1.0, v11
  v_rcp_f32 v10, v10
  v_rcp_f32 v11, v11
  v_mul_f32 v10, v10, v212
  v_mul_f32 v11, v11, v213
  v_mul_f32 v10, v10, v216
  v_mul_f32 v11, v11, v217
  v_cvt_pk_bf16_f32 v10, v10, v11
  s_cmp_eq_u32 s100, 1
  s_cbranch_scc0 st_89_g
  buffer_store_dword v10, v7, s[48:51], s57 offen
  s_branch st_89
st_89_g:
  buffer_store_dword v10, v7, s[48:51], s57 offen sc1
st_89:
L_fin:
  s_cmp_lg_u32 s1, 0
  s_cbranch_scc1 L_fin2
  s_mov_b32 s1, -1
  s_mov_b64 exec, -1
  s_waitcnt vmcnt(0) lgkmcnt(0)
  s_mov_b32 s50, 1064960
  v_mov_b32 v10, 147456
  s_cmp_lg_u32 s9, 1
  s_cbranch_scc1 fb_90
  v_mov_b32 v12, 147644
  s_mov_b32 s58, 12578616
sp_91:
  ds_read_b32 v11, v12
  s_waitcnt lgkmcnt(0)
  v_readfirstlane_b32 s56, v11
  s_cmp_lg_u32 s56, 0
  s_cbranch_scc1 sp_91_ok
  s_sleep 16
  s_sub_u32 s58, s58, 1
  s_cbranch_scc0 sp_91
sp_91_ok:
  s_and_b32 s8, s5, 3
  s_cmp_lg_u32 s8, 3
  s_cbranch_scc1 fb_90_n
  s_lshl_b32 s8, s5, 7
  v_mov_b32 v5, s8
  v_mov_b32 v6, s56
  s_mov_b64 exec, 1
  buffer_store_dword v6, v5, s[48:51], s0 offen offset:16 sc1
  s_mov_b64 exec, -1
fb_90_n:
  s_lshl_b32 s57, s4, 8
  s_add_u32 s57, s57, 459800
  v_mov_b32 v4, 0
  s_cmp_lg_u32 s5, 31
  s_cbranch_scc1 fb_90_c
  buffer_load_dword v6, v4, s[48:51], s57 offen sc1
  s_mov_b32 s58, 12578616
sp_92:
  ds_read_b32 v11, v10
  s_waitcnt lgkmcnt(0)
  v_readfirstlane_b32 s8, v11
  s_cmp_ge_u32 s8, 173
  s_cbranch_scc1 sp_92_ok
  s_sleep 16
  s_sub_u32 s58, s58, 1
  s_cbranch_scc0 sp_92
sp_92_ok:
  v_and_b32 v5, 7, v0
  v_lshlrev_b32 v5, 12, v5
  v_lshrrev_b32 v6, 3, v0
  v_lshl_add_u32 v5, v6, 9, v5
  s_mov_b32 s8, 270736
  buffer_load_dword v6, v5, s[48:51], s8 offen sc1
  s_waitcnt vmcnt(0)
  v_cmp_ne_u32 vcc, -1, v6
  v_sub_u32 v6, s56, v6
  v_bfe_i32 v6, v6, 0, 20
  v_cvt_f32_i32 v6, v6
  v_mov_b32 v7, 0xc3c80000
  v_mov_b32 v8, 0x43c80000
  v_med3_f32 v6, v6, v7, v8
  v_cndmask_b32 v6, 0, v6, vcc
  s_bcnt1_i32_b64 s8, vcc
  s_max_u32 s8, s8, 1
  v_cvt_f32_u32 v8, s8
  v_rcp_f32 v8, v8
  s_nop 1
  v_add_f32 v6, v6, v6 row_ror:1 row_mask:0xf bank_mask:0xf
  s_nop 1
  v_add_f32 v6, v6, v6 row_ror:2 row_mask:0xf bank_mask:0xf
  s_nop 1
  v_add_f32 v6, v6, v6 row_ror:4 row_mask:0xf bank_mask:0xf
  s_nop 1
  v_add_f32 v6, v6, v6 row_ror:8 row_mask:0xf bank_mask:0xf
  v_mov_b32 v7, v6
  s_nop 1
  v_permlane16_swap_b32 v6, v7
  v_add_f32 v6, v6, v7
  v_mov_b32 v7, v6
  s_nop 1
  v_permlane32_swap_b32 v6, v7
  v_add_f32 v6, v6, v7
  v_mul_f32 v6, v6, v8
  v_cvt_i32_f32 v6, v6
  v_sub_u32 v6, s56, v6
  ds_read_b32 v9, v12 offset:40
  s_waitcnt lgkmcnt(0)
  v_sub_u32 v9, v6, v9
  v_sub_u32 v7, v9, v252
  v_bfe_i32 v7, v7, 0, 20
  v_cvt_f32_i32 v7, v7
  v_mul_f32 v7, 0x414ccccd, v7
  v_cvt_i32_f32 v7, v7
  v_max_i32 v7, 10240, v7
  v_min_i32 v7, 30720, v7
  v_mov_b32 v252, v9
  v_mul_u32_u24 v8, 86, v7
  v_lshrrev_b32 v8, 8, v8
  v_sub_u32 v6, v6, v8
  s_mov_b64 exec, 1
  buffer_store_dwordx2 v[6:7], v4, s[48:51], s57 offen
  s_branch fb_90_d
fb_90_c:
  s_mov_b32 s58, 12578616
sp_93:
  ds_read_b32 v11, v10
  s_waitcnt lgkmcnt(0)
  v_readfirstlane_b32 s8, v11
  s_cmp_ge_u32 s8, 177
  s_cbranch_scc1 sp_93_ok
  s_sleep 16
  s_sub_u32 s58, s58, 1
  s_cbranch_scc0 sp_93
sp_93_ok:
  s_mov_b32 s58, 8
  s_mov_b64 exec, 1
fb_90_p:
  buffer_load_dwordx2 v[6:7], v4, s[48:51], s57 offen sc1
  s_waitcnt vmcnt(0)
  v_readfirstlane_b32 s8, v7
  s_cmp_lg_u32 s8, -1
  s_cbranch_scc1 fb_90_d
  s_sleep 16
  s_sub_u32 s58, s58, 1
  s_cbranch_scc0 fb_90_p
  s_branch fb_90_e
fb_90_d:
  v_mov_b32 v9, 147512
  ds_write_b64 v9, v[6:7]
fb_90_e:
  s_mov_b64 exec, -1
fb_90:
  s_cmp_lg_u32 s9, 1
  s_cbranch_scc1 fb_94
  v_mov_b32 v12, 147648
  s_mov_b32 s58, 12578616
sp_95:
  ds_read_b32 v11, v12
  s_waitcnt lgkmcnt(0)
  v_readfirstlane_b32 s56, v11
  s_cmp_lg_u32 s56, 0
  s_cbranch_scc1 sp_95_ok
  s_sleep 16
  s_sub_u32 s58, s58, 1
  s_cbranch_scc0 sp_95
sp_95_ok:
  s_and_b32 s8, s5, 3
  s_cmp_lg_u32 s8, 0
  s_cbranch_scc1 fb_94_n
  s_lshl_b32 s8, s5, 7
  v_mov_b32 v5, s8
  v_mov_b32 v6, s56
  s_mov_b64 exec, 1
  buffer_store_dword v6, v5, s[48:51], s0 offen offset:20 sc1
  s_mov_b64 exec, -1
fb_94_n:
  s_lshl_b32 s57, s4, 8
  s_add_u32 s57, s57, 459808
  v_mov_b32 v4, 0
  s_cmp_lg_u32 s5, 31
  s_cbranch_scc1 fb_94_c
  buffer_load_dword v6, v4, s[48:51], s57 offen sc1
  s_mov_b32 s58, 12578616
sp_96:
  ds_read_b32 v11, v10
  s_waitcnt lgkmcnt(0)
  v_readfirstlane_b32 s8, v11
  s_cmp_ge_u32 s8, 209
  s_cbranch_scc1 sp_96_ok
  s_sleep 16
  s_sub_u32 s58, s58, 1
  s_cbranch_scc0 sp_96
sp_96_ok:
  v_and_b32 v5, 7, v0
  v_lshlrev_b32 v5, 12, v5
  v_lshrrev_b32 v6, 3, v0
  v_lshl_add_u32 v5, v6, 9, v5
  s_mov_b32 s8, 270356
  buffer_load_dword v6, v5, s[48:51], s8 offen sc1
  s_waitcnt vmcnt(0)
  v_cmp_ne_u32 vcc, -1, v6
  v_sub_u32 v6, s56, v6
  v_bfe_i32 v6, v6, 0, 20
  v_cvt_f32_i32 v6, v6
  v_mov_b32 v7, 0xc3c80000
  v_mov_b32 v8, 0x43c80000
  v_med3_f32 v6, v6, v7, v8
  v_cndmask_b32 v6, 0, v6, vcc
  s_bcnt1_i32_b64 s8, vcc
  s_max_u32 s8, s8, 1
  v_cvt_f32_u32 v8, s8
  v_rcp_f32 v8, v8
  s_nop 1
  v_add_f32 v6, v6, v6 row_ror:1 row_mask:0xf bank_mask:0xf
  s_nop 1
  v_add_f32 v6, v6, v6 row_ror:2 row_mask:0xf bank_mask:0xf
  s_nop 1
  v_add_f32 v6, v6, v6 row_ror:4 row_mask:0xf bank_mask:0xf
  s_nop 1
  v_add_f32 v6, v6, v6 row_ror:8 row_mask:0xf bank_mask:0xf
  v_mov_b32 v7, v6
  s_nop 1
  v_permlane16_swap_b32 v6, v7
  v_add_f32 v6, v6, v7
  v_mov_b32 v7, v6
  s_nop 1
  v_permlane32_swap_b32 v6, v7
  v_add_f32 v6, v6, v7
  v_mul_f32 v6, v6, v8
  v_cvt_i32_f32 v6, v6
  v_sub_u32 v6, s56, v6
  ds_read_b32 v9, v12 offset:40
  s_waitcnt lgkmcnt(0)
  v_sub_u32 v9, v6, v9
  v_sub_u32 v7, v9, v252
  v_bfe_i32 v7, v7, 0, 20
  v_cvt_f32_i32 v7, v7
  v_mul_f32 v7, 0x41638e39, v7
  v_cvt_i32_f32 v7, v7
  v_max_i32 v7, 10240, v7
  v_min_i32 v7, 30720, v7
  v_mov_b32 v252, v9
  v_mul_u32_u24 v8, 104, v7
  v_lshrrev_b32 v8, 8, v8
  v_sub_u32 v6, v6, v8
  s_mov_b64 exec, 1
  buffer_store_dwordx2 v[6:7], v4, s[48:51], s57 offen
  s_branch fb_94_d
fb_94_c:
  s_mov_b32 s58, 12578616
sp_97:
  ds_read_b32 v11, v10
  s_waitcnt lgkmcnt(0)
  v_readfirstlane_b32 s8, v11
  s_cmp_ge_u32 s8, 213
  s_cbranch_scc1 sp_97_ok
  s_sleep 16
  s_sub_u32 s58, s58, 1
  s_cbranch_scc0 sp_97
sp_97_ok:
  s_mov_b32 s58, 8
  s_mov_b64 exec, 1
fb_94_p:
  buffer_load_dwordx2 v[6:7], v4, s[48:51], s57 offen sc1
  s_waitcnt vmcnt(0)
  v_readfirstlane_b32 s8, v7
  s_cmp_lg_u32 s8, -1
  s_cbranch_scc1 fb_94_d
  s_sleep 16
  s_sub_u32 s58, s58, 1
  s_cbranch_scc0 fb_94_p
  s_branch fb_94_e
fb_94_d:
  v_mov_b32 v9, 147512
  ds_write_b64 v9, v[6:7]
fb_94_e:
  s_mov_b64 exec, -1
fb_94:
  s_branch L_tail
L_fin2:
L_end:
  s_endpgm
.section .rodata,"a"
.p2align 6
.amdhsa_kernel adaLN_cond__gqa_block_cached__glu_gated_geglu__decode_kernel
  .amdhsa_next_free_vgpr 256
  .amdhsa_next_free_sgpr 102
  .amdhsa_accum_offset 256
  .amdhsa_group_segment_fixed_size 0
  .amdhsa_kernarg_size 112
  .amdhsa_user_sgpr_count 2
  .amdhsa_user_sgpr_kernarg_segment_ptr 1
  .amdhsa_system_sgpr_workgroup_id_x 1
  .amdhsa_float_denorm_mode_32 3
  .amdhsa_float_denorm_mode_16_64 3
.end_amdhsa_kernel
```
